```python
import torch

def _softmax(x, axis=-1):
    return torch.softmax(x, dim=axis)
def _gelu(x):
    return torch.nn.functional.gelu(x, approximate="tanh")
def _silu(x):
    return torch.nn.functional.silu(x)
def _sigmoid(x):
    return torch.sigmoid(x)
def _layernorm(x, axis=-1, eps=1e-5):
    m = x.mean(dim=axis, keepdim=True)
    v = x.var(dim=axis, keepdim=True, unbiased=False)
    return (x - m) / torch.sqrt(v + eps)
def _scatter_add(tgt, idx, src, axis=0):
    return tgt.clone().index_add_(axis, idx, src)
def _segment_sum(src, seg, n):
    out = torch.zeros((n,) + src.shape[1:], dtype=src.dtype)
    return out.index_add_(0, seg, src)
def _pad(x, pw):
    flat = tuple(v for pair in reversed(pw) for v in pair)
    return torch.nn.functional.pad(x, flat)

kernel_name = 'sequential_preLN__linear_kernel_hedgehog__dense_activation_gelu__prompt'

def setup_inputs():

    _w = (lambda a: (lambda t: t.to(torch.bfloat16) if t.is_floating_point() else t)(torch.as_tensor(a)))
    def _A_setup():
        B, S, D, H = 1, 2048, 576, 32
        Dh = D // H
        return {
            "x": _w((lambda *s: torch.randn(*s, dtype=torch.bfloat16) * 0.05)(B, S, D)),
            "wqkv": _w((lambda *s: torch.randn(*s, dtype=torch.bfloat16) * 0.2)(D, 3 * D)),
            "w_phi": _w((lambda *s: torch.randn(*s, dtype=torch.bfloat16) * 0.2)(H, Dh, Dh) * (Dh ** -0.5)),
            "wo": _w((lambda *s: torch.randn(*s, dtype=torch.bfloat16) * 0.05)(D, D)),
        }
    _A_in = _A_setup()

    def _B_setup():
        B, S, D, F = 1, 2048, 576, 4608
        return {
            "x": _w((lambda *s: torch.randn(*s, dtype=torch.bfloat16) * 0.05)(B, S, D)),
            "w1": _w((lambda *s: torch.randn(*s, dtype=torch.bfloat16) * 3.2)(D, F) * (D ** -0.5)),
            "b1": _w((lambda *s: torch.randn(*s, dtype=torch.bfloat16) * 0.1)(F) * 0.01),
            "w2": _w((lambda *s: torch.randn(*s, dtype=torch.bfloat16) * 0.1)(F, D) * (F ** -0.5)),
            "b2": _w((lambda *s: torch.randn(*s, dtype=torch.bfloat16) * 0.1)(D) * 0.01),
        }
    _B_in = _B_setup()

    return {
        "A_x": _A_in["x"],
        "A_wqkv": _A_in["wqkv"],
        "A_w_phi": _A_in["w_phi"],
        "A_wo": _A_in["wo"],
        "B_x": _B_in["x"],
        "B_w1": _B_in["w1"],
        "B_b1": _B_in["b1"],
        "B_w2": _B_in["w2"],
        "B_b2": _B_in["b2"],
    }

def reference(A_x, A_wqkv, A_w_phi, A_wo, B_x, B_w1, B_b1, B_w2, B_b2):
    def _A_ref(x, wqkv, w_phi, wo):
        B, S, D = x.shape
        H = 32; Dh = D // H
        qkv = (lambda x, *d: x.permute(*d))((x @ wqkv).reshape(B, S, 3, H, Dh), 2, 0, 3, 1, 4)
        q, k, v = qkv[0], qkv[1], qkv[2]
        pq = torch.einsum("bhsd,hdf->bhsf", q, w_phi)
        pk = torch.einsum("bhsd,hdf->bhsf", k, w_phi)
        phi_q = torch.concatenate([_softmax(pq, axis=-1), _softmax(-pq, axis=-1)], axis=-1)
        phi_k = torch.concatenate([_softmax(pk, axis=-1), _softmax(-pk, axis=-1)], axis=-1)
        kv = torch.einsum("bhsf,bhsd->bhfd", phi_k, v)
        z  = torch.einsum("bhsf->bhf", phi_k)
        num = torch.einsum("bhqf,bhfd->bhqd", phi_q, kv)
        den = torch.einsum("bhqf,bhf->bhq", phi_q, z)[..., None] + 1e-6
        o = num / den
        return (lambda x, *d: x.permute(*d))(o, 0, 2, 1, 3).reshape(B, S, D) @ wo

    def _B_ref(x, w1, b1, w2, b2):
        h = torch.einsum("bsd,df->bsf", x, w1) + b1
        h = _gelu(h)
        return torch.einsum("bsf,fd->bsd", h, w2) + b2

    x = A_x
    h = x + _A_ref(_layernorm(x, axis=-1), A_wqkv, A_w_phi, A_wo)
    h2 = h + _B_ref(_layernorm(h, axis=-1), B_w1, B_b1, B_w2, B_b2)
    return h2
```

```asm
; @launch kernel=k0_kernel grid=(362,1,1) block=(256,1,1) lds=36864
; @launch kernel=k1_kernel grid=(256,1,1) block=(512,1,1) lds=156672
; @launch kernel=k2_kernel grid=(256,1,1) block=(256,1,1) lds=98304
; @launch kernel=k3_kernel grid=(256,1,1) block=(256,1,1) lds=147456
.amdgcn_target "amdgcn-amd-amdhsa--gfx950"
.text

.globl k0_kernel
.p2align 8
.type k0_kernel,@function
k0_kernel:
    s_cmp_ge_u32 s2, 362
    s_cbranch_scc1 k0_kernel_done
    s_load_dwordx8 s[8:15], s[0:1], 0
    s_load_dwordx4 s[16:19], s[0:1], 40
    s_load_dwordx2 s[20:21], s[0:1], 56
    s_load_dwordx2 s[22:23], s[0:1], 88
    v_lshrrev_b32 v2, 6, v0
    v_and_b32 v1, 63, v0
    v_readfirstlane_b32 s36, v2
    s_waitcnt lgkmcnt(0)
    s_cmp_ge_u32 s2, 256
    s_cbranch_scc1 k0_kernel_nocpf
    s_lshr_b32 s46, s2, 3
    s_lshl_b32 s46, s46, 2
    s_add_u32 s46, s46, s36
    v_lshlrev_b32 v140, 4, v1
    s_getpc_b64 s[56:57]
Lpc_k0:
    s_add_u32 s56, s56, k1_kernel-Lpc_k0
    s_addc_u32 s57, s57, 0
    s_mov_b32 s58, k3_kernel-k1_kernel
    s_mov_b32 s59, 0x00020000
    s_mul_i32 s60, s46, 1024
    buffer_load_dwordx4 v[136:139], v140, s[56:59], s60 offen
k0_kernel_nocpf:
    s_cmp_lt_u32 s2, 128
    s_cbranch_scc1 k0_kernel_A
    s_cmp_lt_u32 s2, 256
    s_cbranch_scc1 k0_kernel_B
    s_cmp_lt_u32 s2, 288
    s_cbranch_scc1 k0_kernel_C
    s_cmp_lt_u32 s2, 320
    s_cbranch_scc1 k0_kernel_E
    s_cmp_lt_u32 s2, 338
    s_cbranch_scc1 k0_kernel_F
    s_branch k0_kernel_H
k0_kernel_A:
    s_mov_b32 s24, s8
    s_mov_b32 s25, s9
    s_mov_b32 s26, 0x240000
    s_mov_b32 s27, 0x00020000
    s_add_u32 s28, s22, 0xc800000
    s_addc_u32 s29, s23, 0
    s_mov_b32 s30, 0x240000
    s_mov_b32 s31, 0x00020000
    v_lshrrev_b32 v2, 4, v1
    v_and_b32 v3, 15, v1
    s_lshl_b32 s37, s2, 4
    s_lshl_b32 s38, s36, 2
    s_add_u32 s37, s37, s38
    v_add_u32 v4, s37, v2
    v_mul_u32_u24 v4, 1152, v4
    v_lshl_add_u32 v4, v3, 4, v4
    buffer_load_dwordx4 v[8:11], v4, s[24:27], 0 offen offset:0
    buffer_load_dwordx4 v[12:15], v4, s[24:27], 0 offen offset:256
    buffer_load_dwordx4 v[16:19], v4, s[24:27], 0 offen offset:512
    buffer_load_dwordx4 v[20:23], v4, s[24:27], 0 offen offset:768
    v_mov_b32 v5, 0x40000000
    v_cmp_gt_u32 vcc, 8, v3
    s_nop 1
    v_cndmask_b32 v5, v5, v4, vcc
    buffer_load_dwordx4 v[24:27], v5, s[24:27], 0 offen offset:1024
    v_mov_b32 v51, 0xffff0000
    v_mov_b32 v46, 0
    v_mov_b32 v47, 0
    v_mov_b32 v48, 0
    v_mov_b32 v49, 0
    s_waitcnt vmcnt(4)
    v_lshlrev_b32 v64, 16, v8
    v_and_b32 v65, v51, v8
    v_lshlrev_b32 v66, 16, v9
    v_and_b32 v67, v51, v9
    v_lshlrev_b32 v68, 16, v10
    v_and_b32 v69, v51, v10
    v_lshlrev_b32 v70, 16, v11
    v_and_b32 v71, v51, v11
    v_add_f32 v46, v46, v64
    v_add_f32 v48, v48, v65
    v_add_f32 v47, v47, v66
    v_add_f32 v49, v49, v67
    v_add_f32 v46, v46, v68
    v_add_f32 v48, v48, v69
    v_add_f32 v47, v47, v70
    v_add_f32 v49, v49, v71
    s_waitcnt vmcnt(3)
    v_lshlrev_b32 v72, 16, v12
    v_and_b32 v73, v51, v12
    v_lshlrev_b32 v74, 16, v13
    v_and_b32 v75, v51, v13
    v_lshlrev_b32 v76, 16, v14
    v_and_b32 v77, v51, v14
    v_lshlrev_b32 v78, 16, v15
    v_and_b32 v79, v51, v15
    v_add_f32 v46, v46, v72
    v_add_f32 v48, v48, v73
    v_add_f32 v47, v47, v74
    v_add_f32 v49, v49, v75
    v_add_f32 v46, v46, v76
    v_add_f32 v48, v48, v77
    v_add_f32 v47, v47, v78
    v_add_f32 v49, v49, v79
    s_waitcnt vmcnt(2)
    v_lshlrev_b32 v80, 16, v16
    v_and_b32 v81, v51, v16
    v_lshlrev_b32 v82, 16, v17
    v_and_b32 v83, v51, v17
    v_lshlrev_b32 v84, 16, v18
    v_and_b32 v85, v51, v18
    v_lshlrev_b32 v86, 16, v19
    v_and_b32 v87, v51, v19
    v_add_f32 v46, v46, v80
    v_add_f32 v48, v48, v81
    v_add_f32 v47, v47, v82
    v_add_f32 v49, v49, v83
    v_add_f32 v46, v46, v84
    v_add_f32 v48, v48, v85
    v_add_f32 v47, v47, v86
    v_add_f32 v49, v49, v87
    s_waitcnt vmcnt(1)
    v_lshlrev_b32 v88, 16, v20
    v_and_b32 v89, v51, v20
    v_lshlrev_b32 v90, 16, v21
    v_and_b32 v91, v51, v21
    v_lshlrev_b32 v92, 16, v22
    v_and_b32 v93, v51, v22
    v_lshlrev_b32 v94, 16, v23
    v_and_b32 v95, v51, v23
    v_add_f32 v46, v46, v88
    v_add_f32 v48, v48, v89
    v_add_f32 v47, v47, v90
    v_add_f32 v49, v49, v91
    v_add_f32 v46, v46, v92
    v_add_f32 v48, v48, v93
    v_add_f32 v47, v47, v94
    v_add_f32 v49, v49, v95
    s_waitcnt vmcnt(0)
    v_lshlrev_b32 v96, 16, v24
    v_and_b32 v97, v51, v24
    v_lshlrev_b32 v98, 16, v25
    v_and_b32 v99, v51, v25
    v_lshlrev_b32 v100, 16, v26
    v_and_b32 v101, v51, v26
    v_lshlrev_b32 v102, 16, v27
    v_and_b32 v103, v51, v27
    v_add_f32 v46, v46, v96
    v_add_f32 v48, v48, v97
    v_add_f32 v47, v47, v98
    v_add_f32 v49, v49, v99
    v_add_f32 v46, v46, v100
    v_add_f32 v48, v48, v101
    v_add_f32 v47, v47, v102
    v_add_f32 v49, v49, v103
    v_add_f32 v46, v46, v47
    v_add_f32 v48, v48, v49
    v_add_f32 v46, v46, v48
    s_nop 1
    v_add_f32_dpp v46, v46, v46 quad_perm:[1,0,3,2] row_mask:0xf bank_mask:0xf
    s_nop 1
    v_add_f32_dpp v46, v46, v46 quad_perm:[2,3,0,1] row_mask:0xf bank_mask:0xf
    s_nop 1
    v_add_f32_dpp v46, v46, v46 row_half_mirror row_mask:0xf bank_mask:0xf
    s_nop 1
    v_add_f32_dpp v46, v46, v46 row_mirror row_mask:0xf bank_mask:0xf
    v_mul_f32 v46, 0x3ae38e39, v46
    v_mov_b32 v52, 0
    v_mov_b32 v53, 0
    v_mov_b32 v54, 0
    v_mov_b32 v55, 0
    v_sub_f32 v64, v64, v46
    v_sub_f32 v65, v65, v46
    v_sub_f32 v66, v66, v46
    v_sub_f32 v67, v67, v46
    v_sub_f32 v68, v68, v46
    v_sub_f32 v69, v69, v46
    v_sub_f32 v70, v70, v46
    v_sub_f32 v71, v71, v46
    v_sub_f32 v72, v72, v46
    v_sub_f32 v73, v73, v46
    v_sub_f32 v74, v74, v46
    v_sub_f32 v75, v75, v46
    v_sub_f32 v76, v76, v46
    v_sub_f32 v77, v77, v46
    v_sub_f32 v78, v78, v46
    v_sub_f32 v79, v79, v46
    v_sub_f32 v80, v80, v46
    v_sub_f32 v81, v81, v46
    v_sub_f32 v82, v82, v46
    v_sub_f32 v83, v83, v46
    v_sub_f32 v84, v84, v46
    v_sub_f32 v85, v85, v46
    v_sub_f32 v86, v86, v46
    v_sub_f32 v87, v87, v46
    v_sub_f32 v88, v88, v46
    v_sub_f32 v89, v89, v46
    v_sub_f32 v90, v90, v46
    v_sub_f32 v91, v91, v46
    v_sub_f32 v92, v92, v46
    v_sub_f32 v93, v93, v46
    v_sub_f32 v94, v94, v46
    v_sub_f32 v95, v95, v46
    v_sub_f32 v96, v96, v46
    v_sub_f32 v97, v97, v46
    v_sub_f32 v98, v98, v46
    v_sub_f32 v99, v99, v46
    v_sub_f32 v100, v100, v46
    v_sub_f32 v101, v101, v46
    v_sub_f32 v102, v102, v46
    v_sub_f32 v103, v103, v46
    v_cmp_gt_u32 vcc, 8, v3
    s_nop 1
    v_cndmask_b32 v96, 0, v96, vcc
    v_cndmask_b32 v97, 0, v97, vcc
    v_cndmask_b32 v98, 0, v98, vcc
    v_cndmask_b32 v99, 0, v99, vcc
    v_cndmask_b32 v100, 0, v100, vcc
    v_cndmask_b32 v101, 0, v101, vcc
    v_cndmask_b32 v102, 0, v102, vcc
    v_cndmask_b32 v103, 0, v103, vcc
    v_fmac_f32 v52, v64, v64
    v_fmac_f32 v53, v65, v65
    v_fmac_f32 v54, v66, v66
    v_fmac_f32 v55, v67, v67
    v_fmac_f32 v52, v68, v68
    v_fmac_f32 v53, v69, v69
    v_fmac_f32 v54, v70, v70
    v_fmac_f32 v55, v71, v71
    v_fmac_f32 v52, v72, v72
    v_fmac_f32 v53, v73, v73
    v_fmac_f32 v54, v74, v74
    v_fmac_f32 v55, v75, v75
    v_fmac_f32 v52, v76, v76
    v_fmac_f32 v53, v77, v77
    v_fmac_f32 v54, v78, v78
    v_fmac_f32 v55, v79, v79
    v_fmac_f32 v52, v80, v80
    v_fmac_f32 v53, v81, v81
    v_fmac_f32 v54, v82, v82
    v_fmac_f32 v55, v83, v83
    v_fmac_f32 v52, v84, v84
    v_fmac_f32 v53, v85, v85
    v_fmac_f32 v54, v86, v86
    v_fmac_f32 v55, v87, v87
    v_fmac_f32 v52, v88, v88
    v_fmac_f32 v53, v89, v89
    v_fmac_f32 v54, v90, v90
    v_fmac_f32 v55, v91, v91
    v_fmac_f32 v52, v92, v92
    v_fmac_f32 v53, v93, v93
    v_fmac_f32 v54, v94, v94
    v_fmac_f32 v55, v95, v95
    v_fmac_f32 v52, v96, v96
    v_fmac_f32 v53, v97, v97
    v_fmac_f32 v54, v98, v98
    v_fmac_f32 v55, v99, v99
    v_fmac_f32 v52, v100, v100
    v_fmac_f32 v53, v101, v101
    v_fmac_f32 v54, v102, v102
    v_fmac_f32 v55, v103, v103
    v_add_f32 v52, v52, v53
    v_add_f32 v54, v54, v55
    v_add_f32 v52, v52, v54
    s_nop 1
    v_add_f32_dpp v52, v52, v52 quad_perm:[1,0,3,2] row_mask:0xf bank_mask:0xf
    s_nop 1
    v_add_f32_dpp v52, v52, v52 quad_perm:[2,3,0,1] row_mask:0xf bank_mask:0xf
    s_nop 1
    v_add_f32_dpp v52, v52, v52 row_half_mirror row_mask:0xf bank_mask:0xf
    s_nop 1
    v_add_f32_dpp v52, v52, v52 row_mirror row_mask:0xf bank_mask:0xf
    v_mov_b32 v53, 0x3727c5ac
    v_fmac_f32 v53, 0x3ae38e39, v52
    v_rsq_f32 v53, v53
    s_nop 0
    v_mul_f32 v64, v53, v64
    v_mul_f32 v65, v53, v65
    v_cvt_pk_bf16_f32 v8, v64, v65
    v_mul_f32 v66, v53, v66
    v_mul_f32 v67, v53, v67
    v_cvt_pk_bf16_f32 v9, v66, v67
    v_mul_f32 v68, v53, v68
    v_mul_f32 v69, v53, v69
    v_cvt_pk_bf16_f32 v10, v68, v69
    v_mul_f32 v70, v53, v70
    v_mul_f32 v71, v53, v71
    v_cvt_pk_bf16_f32 v11, v70, v71
    v_mul_f32 v72, v53, v72
    v_mul_f32 v73, v53, v73
    v_cvt_pk_bf16_f32 v12, v72, v73
    v_mul_f32 v74, v53, v74
    v_mul_f32 v75, v53, v75
    v_cvt_pk_bf16_f32 v13, v74, v75
    v_mul_f32 v76, v53, v76
    v_mul_f32 v77, v53, v77
    v_cvt_pk_bf16_f32 v14, v76, v77
    v_mul_f32 v78, v53, v78
    v_mul_f32 v79, v53, v79
    v_cvt_pk_bf16_f32 v15, v78, v79
    v_mul_f32 v80, v53, v80
    v_mul_f32 v81, v53, v81
    v_cvt_pk_bf16_f32 v16, v80, v81
    v_mul_f32 v82, v53, v82
    v_mul_f32 v83, v53, v83
    v_cvt_pk_bf16_f32 v17, v82, v83
    v_mul_f32 v84, v53, v84
    v_mul_f32 v85, v53, v85
    v_cvt_pk_bf16_f32 v18, v84, v85
    v_mul_f32 v86, v53, v86
    v_mul_f32 v87, v53, v87
    v_cvt_pk_bf16_f32 v19, v86, v87
    v_mul_f32 v88, v53, v88
    v_mul_f32 v89, v53, v89
    v_cvt_pk_bf16_f32 v20, v88, v89
    v_mul_f32 v90, v53, v90
    v_mul_f32 v91, v53, v91
    v_cvt_pk_bf16_f32 v21, v90, v91
    v_mul_f32 v92, v53, v92
    v_mul_f32 v93, v53, v93
    v_cvt_pk_bf16_f32 v22, v92, v93
    v_mul_f32 v94, v53, v94
    v_mul_f32 v95, v53, v95
    v_cvt_pk_bf16_f32 v23, v94, v95
    v_mul_f32 v96, v53, v96
    v_mul_f32 v97, v53, v97
    v_cvt_pk_bf16_f32 v24, v96, v97
    v_mul_f32 v98, v53, v98
    v_mul_f32 v99, v53, v99
    v_cvt_pk_bf16_f32 v25, v98, v99
    v_mul_f32 v100, v53, v100
    v_mul_f32 v101, v53, v101
    v_cvt_pk_bf16_f32 v26, v100, v101
    v_mul_f32 v102, v53, v102
    v_mul_f32 v103, v53, v103
    v_cvt_pk_bf16_f32 v27, v102, v103
    s_lshl_b32 s38, s36, 2
    v_add_u32 v4, s38, v2
    v_and_b32 v5, 7, v3
    v_xor_b32 v4, v4, v5
    v_lshlrev_b32 v4, 4, v4
    v_lshl_add_u32 v4, v3, 8, v4
    ds_write_b128 v4, v[8:11] offset:0
    ds_write_b128 v4, v[12:15] offset:4096
    ds_write_b128 v4, v[16:19] offset:8192
    ds_write_b128 v4, v[20:23] offset:12288
    s_mov_b64 s[40:41], exec
    v_cmp_gt_u32 vcc, 8, v3
    s_mov_b64 exec, vcc
    ds_write_b128 v4, v[24:27] offset:16384
    s_mov_b64 exec, s[40:41]
    v_lshrrev_b32 v5, 5, v1
    v_bfe_u32 v6, v1, 4, 1
    v_and_b32 v7, 15, v1
    v_lshl_add_u32 v2, v5, 1, v6
    s_lshl_b32 s38, s36, 2
    v_add_u32 v2, s38, v2
    v_and_b32 v2, 7, v2
    v_xor_b32 v2, v7, v2
    v_lshlrev_b32 v2, 4, v2
    v_lshl_add_u32 v2, v6, 8, v2
    v_lshl_add_u32 v2, v5, 9, v2
    s_lshl_b32 s38, s36, 10
    v_add_u32 v2, s38, v2
    v_lshlrev_b32 v3, 4, v7
    v_lshl_add_u32 v3, v6, 9, v3
    v_lshl_add_u32 v3, v5, 10, v3
    s_and_b32 s38, s2, 1
    s_lshl_b32 s38, s38, 8
    s_lshr_b32 s37, s2, 1
    s_mul_i32 s37, s37, 36864
    s_add_u32 s37, s37, s38
    s_lshl_b32 s38, s36, 11
    s_add_u32 s37, s37, s38
    s_waitcnt lgkmcnt(0)
    s_barrier
    ds_read_b128 v[8:11], v2 offset:0
    ds_read_b128 v[12:15], v2 offset:4096
    ds_read_b128 v[16:19], v2 offset:8192
    ds_read_b128 v[20:23], v2 offset:12288
    s_cmp_lt_u32 s36, 2
    s_cbranch_scc0 k0_kernel_A4
    ds_read_b128 v[24:27], v2 offset:16384
k0_kernel_A4:
    s_waitcnt lgkmcnt(0)
    buffer_store_dwordx4 v[8:11], v3, s[28:31], s37 offen
    s_add_u32 s37, s37, 8192
    buffer_store_dwordx4 v[12:15], v3, s[28:31], s37 offen
    s_add_u32 s37, s37, 8192
    buffer_store_dwordx4 v[16:19], v3, s[28:31], s37 offen
    s_add_u32 s37, s37, 8192
    buffer_store_dwordx4 v[20:23], v3, s[28:31], s37 offen
    s_add_u32 s37, s37, 8192
    s_cmp_lt_u32 s36, 2
    s_cbranch_scc0 k0_kernel_A5
    buffer_store_dwordx4 v[24:27], v3, s[28:31], s37 offen
k0_kernel_A5:
    s_endpgm
k0_kernel_B:
    s_mov_b32 s24, s10
    s_mov_b32 s25, s11
    s_mov_b32 s26, 0x1e6000
    s_mov_b32 s27, 0x00020000
    s_add_u32 s28, s22, 0xca40000
    s_addc_u32 s29, s23, 0
    s_mov_b32 s30, 0x240000
    s_mov_b32 s31, 0x00020000
    s_sub_u32 s37, s2, 128
    s_lshr_b32 s38, s37, 2
    s_and_b32 s39, s37, 3
    v_and_b32 v2, 31, v1
    v_lshrrev_b32 v3, 5, v1
    v_mul_u32_u24 v4, 57, v2
    v_lshrrev_b32 v4, 9, v4
    v_mul_u32_u24 v5, 9, v4
    v_sub_u32 v5, v2, v5
    v_mul_u32_u24 v4, 1152, v4
    v_lshl_add_u32 v4, v5, 2, v4
    v_mul_u32_u24 v5, 3456, v3
    v_add_u32 v4, v4, v5
    v_mov_b32 v5, 0x40000000
    v_cmp_gt_u32 vcc, 27, v2
    s_nop 1
    v_cndmask_b32 v4, v5, v4, vcc
    s_mul_i32 s40, s39, 497664
    s_mul_i32 s41, s38, 36
    s_add_u32 s40, s40, s41
    s_mul_i32 s41, s36, 6912
    s_add_u32 s40, s40, s41
    s_lshl_b32 s42, s36, 8
    s_mov_b32 m0, s42
    s_add_u32 s42, s42, 1024
    buffer_load_dword v4, s[24:27], s40 offen  lds
    s_add_u32 s40, s40, 27648
    s_mov_b32 m0, s42
    s_add_u32 s42, s42, 1024
    buffer_load_dword v4, s[24:27], s40 offen  lds
    s_add_u32 s40, s40, 27648
    s_mov_b32 m0, s42
    s_add_u32 s42, s42, 1024
    buffer_load_dword v4, s[24:27], s40 offen  lds
    s_add_u32 s40, s40, 27648
    s_mov_b32 m0, s42
    s_add_u32 s42, s42, 1024
    buffer_load_dword v4, s[24:27], s40 offen  lds
    s_add_u32 s40, s40, 27648
    s_mov_b32 m0, s42
    s_add_u32 s42, s42, 1024
    buffer_load_dword v4, s[24:27], s40 offen  lds
    s_add_u32 s40, s40, 27648
    s_mov_b32 m0, s42
    s_add_u32 s42, s42, 1024
    buffer_load_dword v4, s[24:27], s40 offen  lds
    s_add_u32 s40, s40, 27648
    s_mov_b32 m0, s42
    s_add_u32 s42, s42, 1024
    buffer_load_dword v4, s[24:27], s40 offen  lds
    s_add_u32 s40, s40, 27648
    s_mov_b32 m0, s42
    s_add_u32 s42, s42, 1024
    buffer_load_dword v4, s[24:27], s40 offen  lds
    s_add_u32 s40, s40, 27648
    s_mov_b32 m0, s42
    s_add_u32 s42, s42, 1024
    buffer_load_dword v4, s[24:27], s40 offen  lds
    s_add_u32 s40, s40, 27648
    s_mov_b32 m0, s42
    s_add_u32 s42, s42, 1024
    buffer_load_dword v4, s[24:27], s40 offen  lds
    s_add_u32 s40, s40, 27648
    s_mov_b32 m0, s42
    s_add_u32 s42, s42, 1024
    buffer_load_dword v4, s[24:27], s40 offen  lds
    s_add_u32 s40, s40, 27648
    s_mov_b32 m0, s42
    s_add_u32 s42, s42, 1024
    buffer_load_dword v4, s[24:27], s40 offen  lds
    s_add_u32 s40, s40, 27648
    s_mov_b32 m0, s42
    s_add_u32 s42, s42, 1024
    buffer_load_dword v4, s[24:27], s40 offen  lds
    s_add_u32 s40, s40, 27648
    s_mov_b32 m0, s42
    s_add_u32 s42, s42, 1024
    buffer_load_dword v4, s[24:27], s40 offen  lds
    s_add_u32 s40, s40, 27648
    s_mov_b32 m0, s42
    s_add_u32 s42, s42, 1024
    buffer_load_dword v4, s[24:27], s40 offen  lds
    s_add_u32 s40, s40, 27648
    s_mov_b32 m0, s42
    s_add_u32 s42, s42, 1024
    buffer_load_dword v4, s[24:27], s40 offen  lds
    s_add_u32 s40, s40, 27648
    s_mov_b32 m0, s42
    s_add_u32 s42, s42, 1024
    buffer_load_dword v4, s[24:27], s40 offen  lds
    s_add_u32 s40, s40, 27648
    s_mov_b32 m0, s42
    s_add_u32 s42, s42, 1024
    buffer_load_dword v4, s[24:27], s40 offen  lds
    s_add_u32 s40, s40, 27648
    v_lshrrev_b32 v6, 5, v1
    v_lshlrev_b32 v6, 10, v6
    v_bfe_u32 v7, v1, 2, 2
    v_lshl_add_u32 v6, v7, 7, v6
    v_bfe_u32 v7, v1, 4, 1
    v_lshl_add_u32 v6, v7, 5, v6
    v_and_b32 v7, 3, v1
    v_lshl_add_u32 v6, v7, 3, v6
    s_and_b32 s43, s36, 1
    s_lshr_b32 s44, s36, 1
    s_lshl_b32 s45, s43, 6
    s_lshl_b32 s46, s44, 11
    s_add_u32 s45, s45, s46
    v_add_u32 v6, s45, v6
    s_mul_i32 s45, s38, 72
    s_mul_i32 s46, s39, 18
    s_add_u32 s45, s45, s46
    s_lshl_b32 s46, s44, 1
    s_add_u32 s45, s45, s46
    s_add_u32 s45, s45, s43
    s_lshl_b32 s45, s45, 10
    v_lshlrev_b32 v7, 4, v1
    s_waitcnt vmcnt(0)
    s_barrier
    ds_read_b64_tr_b16 v[8:9], v6 offset:0
    ds_read_b64_tr_b16 v[10:11], v6 offset:512
    ds_read_b64_tr_b16 v[12:13], v6 offset:4096
    ds_read_b64_tr_b16 v[14:15], v6 offset:4608
    ds_read_b64_tr_b16 v[16:17], v6 offset:8192
    ds_read_b64_tr_b16 v[18:19], v6 offset:8704
    ds_read_b64_tr_b16 v[20:21], v6 offset:12288
    ds_read_b64_tr_b16 v[22:23], v6 offset:12800
    s_waitcnt lgkmcnt(6)
    buffer_store_dwordx4 v[8:11], v7, s[28:31], s45 offen
    s_add_u32 s45, s45, 4096
    s_waitcnt lgkmcnt(4)
    buffer_store_dwordx4 v[12:15], v7, s[28:31], s45 offen
    s_add_u32 s45, s45, 4096
    s_waitcnt lgkmcnt(2)
    buffer_store_dwordx4 v[16:19], v7, s[28:31], s45 offen
    s_add_u32 s45, s45, 4096
    s_waitcnt lgkmcnt(0)
    buffer_store_dwordx4 v[20:23], v7, s[28:31], s45 offen
    s_add_u32 s45, s45, 4096
    s_cmp_ge_u32 s36, 2
    s_cbranch_scc1 k0_kernel_Bend
    ds_read_b64_tr_b16 v[24:25], v6 offset:16384
    ds_read_b64_tr_b16 v[26:27], v6 offset:16896
    s_waitcnt lgkmcnt(0)
    buffer_store_dwordx4 v[24:27], v7, s[28:31], s45 offen
k0_kernel_Bend:
    s_endpgm
k0_kernel_C:
    s_mov_b32 s24, s12
    s_mov_b32 s25, s13
    s_mov_b32 s26, 0x5100
    s_mov_b32 s27, 0x00020000
    s_add_u32 s28, s22, 0xcc80000
    s_addc_u32 s29, s23, 0
    s_mov_b32 s30, 0x30000
    s_mov_b32 s31, 0x00020000
    s_sub_u32 s37, s2, 256
    v_mov_b32 v8, 0
    v_mov_b32 v9, 0
    v_mul_u32_u24 v2, 24, v0
    ds_write_b64 v2, v[8:9]
    ds_write_b64 v2, v[8:9] offset:8
    ds_write_b64 v2, v[8:9] offset:16
    s_mul_i32 s38, s37, 648
    v_add_u32 v10, 0, v0
    v_mul_u32_u24 v11, 3641, v10
    v_lshrrev_b32 v11, 16, v11
    v_mul_u32_u24 v12, 18, v11
    v_sub_u32 v12, v10, v12
    v_lshlrev_b32 v16, 1, v10
    v_mov_b32 v30, 0x40000000
    v_cmp_gt_u32 vcc, 324, v10
    s_nop 1
    v_cndmask_b32 v16, v30, v16, vcc
    buffer_load_ushort v13, v16, s[24:27], s38 offen
    v_lshrrev_b32 v31, 4, v12
    v_lshlrev_b32 v31, 5, v31
    v_bfe_u32 v32, v12, 2, 2
    v_lshl_add_u32 v31, v32, 3, v31
    v_and_b32 v32, 3, v12
    v_add_u32 v31, v31, v32
    v_mul_u32_u24 v31, 96, v31
    v_and_b32 v34, 0x33, v11
    v_bfe_u32 v33, v11, 2, 1
    v_lshl_add_u32 v34, v33, 3, v34
    v_bfe_u32 v33, v11, 3, 1
    v_lshl_add_u32 v34, v33, 2, v34
    v_lshl_add_u32 v14, v34, 1, v31
    v_add_u32 v35, 18, v11
    v_and_b32 v34, 0x33, v35
    v_bfe_u32 v33, v35, 2, 1
    v_lshl_add_u32 v34, v33, 3, v34
    v_bfe_u32 v33, v35, 3, 1
    v_lshl_add_u32 v34, v33, 2, v34
    v_lshl_add_u32 v15, v34, 1, v31
    v_add_u32 v15, 384, v15
    v_add_u32 v18, 256, v0
    v_mul_u32_u24 v19, 3641, v18
    v_lshrrev_b32 v19, 16, v19
    v_mul_u32_u24 v20, 18, v19
    v_sub_u32 v20, v18, v20
    v_lshlrev_b32 v24, 1, v18
    v_mov_b32 v30, 0x40000000
    v_cmp_gt_u32 vcc, 324, v18
    s_nop 1
    v_cndmask_b32 v24, v30, v24, vcc
    buffer_load_ushort v21, v24, s[24:27], s38 offen
    v_lshrrev_b32 v31, 4, v20
    v_lshlrev_b32 v31, 5, v31
    v_bfe_u32 v32, v20, 2, 2
    v_lshl_add_u32 v31, v32, 3, v31
    v_and_b32 v32, 3, v20
    v_add_u32 v31, v31, v32
    v_mul_u32_u24 v31, 96, v31
    v_and_b32 v34, 0x33, v19
    v_bfe_u32 v33, v19, 2, 1
    v_lshl_add_u32 v34, v33, 3, v34
    v_bfe_u32 v33, v19, 3, 1
    v_lshl_add_u32 v34, v33, 2, v34
    v_lshl_add_u32 v22, v34, 1, v31
    v_add_u32 v35, 18, v19
    v_and_b32 v34, 0x33, v35
    v_bfe_u32 v33, v35, 2, 1
    v_lshl_add_u32 v34, v33, 3, v34
    v_bfe_u32 v33, v35, 3, 1
    v_lshl_add_u32 v34, v33, 2, v34
    v_lshl_add_u32 v23, v34, 1, v31
    v_add_u32 v23, 384, v23
    s_waitcnt lgkmcnt(0)
    s_barrier
    s_waitcnt vmcnt(0)
    ds_write_b16 v14, v13
    ds_write_b16 v15, v13
    v_cmp_gt_u32 vcc, 68, v0
    s_and_saveexec_b64 s[40:41], vcc
    s_cbranch_execz k0_kernel_C2
    ds_write_b16 v22, v21
    ds_write_b16 v23, v21
k0_kernel_C2:
    s_mov_b64 exec, s[40:41]
    s_waitcnt lgkmcnt(0)
    s_barrier
    v_and_b32 v2, 31, v1
    v_mul_u32_u24 v2, 96, v2
    v_lshrrev_b32 v3, 5, v1
    v_lshl_add_u32 v2, v3, 4, v2
    v_lshlrev_b32 v7, 4, v1
    s_add_u32 s39, s36, 0
    s_cmp_ge_u32 s39, 3
    s_cselect_b32 s40, 1, 0
    s_mul_i32 s41, s40, 3
    s_sub_u32 s41, s39, s41
    s_mul_i32 s40, s40, 3072
    s_lshl_b32 s41, s41, 5
    s_add_u32 s40, s40, s41
    v_add_u32 v4, s40, v2
    ds_read_b128 v[8:11], v4
    s_mul_i32 s42, s37, 6
    s_add_u32 s42, s42, s39
    s_lshl_b32 s42, s42, 10
    s_waitcnt lgkmcnt(0)
    buffer_store_dwordx4 v[8:11], v7, s[28:31], s42 offen
    s_waitcnt vmcnt(0)
    s_cmp_ge_u32 s36, 2
    s_cbranch_scc1 k0_kernel_Cend
    s_add_u32 s39, s36, 4
    s_cmp_ge_u32 s39, 3
    s_cselect_b32 s40, 1, 0
    s_mul_i32 s41, s40, 3
    s_sub_u32 s41, s39, s41
    s_mul_i32 s40, s40, 3072
    s_lshl_b32 s41, s41, 5
    s_add_u32 s40, s40, s41
    v_add_u32 v4, s40, v2
    ds_read_b128 v[8:11], v4
    s_mul_i32 s42, s37, 6
    s_add_u32 s42, s42, s39
    s_lshl_b32 s42, s42, 10
    s_waitcnt lgkmcnt(0)
    buffer_store_dwordx4 v[8:11], v7, s[28:31], s42 offen
    s_waitcnt vmcnt(0)
k0_kernel_Cend:
    s_endpgm
k0_kernel_D:
    s_mov_b32 s24, s16
    s_mov_b32 s25, s17
    s_mov_b32 s26, 0x510000
    s_mov_b32 s27, 0x00020000
    s_add_u32 s28, s22, 0xcd52000
    s_addc_u32 s29, s23, 0
    s_mov_b32 s30, 0x558000
    s_mov_b32 s31, 0x00020000
    s_add_u32 s48, s22, 0xddfa000
    s_addc_u32 s49, s23, 0
    s_mov_b32 s50, 0x51000
    s_mov_b32 s51, 0x00020000
    s_sub_u32 s41, s2, 288
    s_mul_i32 s42, s41, 3641
    s_lshr_b32 s42, s42, 16
    s_mul_i32 s43, s42, 18
    s_sub_u32 s43, s41, s43
    s_mul_i32 s37, s43, 294912
    s_mul_i32 s44, s42, 1152
    s_add_u32 s37, s37, s44
    s_mov_b32 s38, 9216
    s_mul_i32 s39, s42, 684
    s_add_u32 s39, s39, s43
    s_add_u32 s39, s39, 1
    s_mov_b32 s40, 19
    s_mul_i32 s46, s43, 4608
    s_mul_i32 s47, s42, 576
    s_add_u32 s46, s46, s47
    s_lshl_b32 s46, s46, 2
    s_mov_b32 s47, 1
    s_branch k0_kernel_T
k0_kernel_E:
    s_mov_b32 s47, 0
    s_mov_b32 s24, s20
    s_mov_b32 s25, s21
    s_mov_b32 s26, 0x510000
    s_mov_b32 s27, 0x00020000
    s_add_u32 s28, s22, 0xd2aa000
    s_addc_u32 s29, s23, 0
    s_mov_b32 s30, 0x510000
    s_mov_b32 s31, 0x00020000
    s_sub_u32 s41, s2, 176
    s_mul_i32 s42, s41, 3641
    s_lshr_b32 s42, s42, 16
    s_mul_i32 s43, s42, 18
    s_sub_u32 s43, s41, s43
    s_mul_i32 s37, s41, 36864
    s_mov_b32 s38, 1152
    s_mul_i32 s39, s42, 648
    s_add_u32 s39, s39, s43
    s_mov_b32 s40, 18
    s_branch k0_kernel_T
k0_kernel_F:
    s_mov_b32 s47, 0
    s_mov_b32 s24, s14
    s_mov_b32 s25, s15
    s_mov_b32 s26, 0xa2000
    s_mov_b32 s27, 0x00020000
    s_add_u32 s28, s22, 0xccb0000
    s_addc_u32 s29, s23, 0
    s_mov_b32 s30, 0xa2000
    s_mov_b32 s31, 0x00020000
    s_sub_u32 s39, s2, 320
    s_mul_i32 s37, s39, 36864
    s_mov_b32 s38, 1152
    s_mov_b32 s40, 18
k0_kernel_T:
    v_lshrrev_b32 v2, 3, v1
    s_lshl_b32 s41, s36, 3
    v_add_u32 v2, s41, v2
    v_mul_lo_u32 v2, v2, s38
    v_and_b32 v3, 7, v1
    v_lshl_add_u32 v2, v3, 4, v2
    s_mul_i32 s42, s36, 9216
    s_add_u32 m0, s42, 0
    s_nop 0
    buffer_load_dwordx4 v2, s[24:27], s37 offen offset:0  lds
    s_add_u32 m0, s42, 896
    s_nop 0
    buffer_load_dwordx4 v2, s[24:27], s37 offen offset:128  lds
    s_add_u32 m0, s42, 1792
    s_nop 0
    buffer_load_dwordx4 v2, s[24:27], s37 offen offset:256  lds
    s_add_u32 m0, s42, 2688
    s_nop 0
    buffer_load_dwordx4 v2, s[24:27], s37 offen offset:384  lds
    s_add_u32 m0, s42, 3584
    s_nop 0
    buffer_load_dwordx4 v2, s[24:27], s37 offen offset:512  lds
    s_add_u32 m0, s42, 4480
    s_nop 0
    buffer_load_dwordx4 v2, s[24:27], s37 offen offset:640  lds
    s_add_u32 m0, s42, 5376
    s_nop 0
    buffer_load_dwordx4 v2, s[24:27], s37 offen offset:768  lds
    s_add_u32 m0, s42, 6272
    s_nop 0
    buffer_load_dwordx4 v2, s[24:27], s37 offen offset:896  lds
    s_add_u32 m0, s42, 7168
    s_nop 0
    buffer_load_dwordx4 v2, s[24:27], s37 offen offset:1024  lds
    v_lshrrev_b32 v4, 5, v1
    v_mul_u32_u24 v4, 9216, v4
    v_bfe_u32 v5, v1, 4, 1
    v_lshl_add_u32 v4, v5, 9, v4
    v_bfe_u32 v5, v1, 2, 2
    v_lshl_add_u32 v4, v5, 7, v4
    v_and_b32 v5, 3, v1
    v_lshl_add_u32 v4, v5, 3, v4
    s_lshl_b32 s43, s36, 5
    v_add_u32 v4, s43, v4
    s_mul_i32 s43, s36, s40
    s_add_u32 s43, s43, s39
    s_lshl_b32 s43, s43, 10
    s_lshl_b32 s44, s40, 12
    v_lshlrev_b32 v7, 4, v1
    s_waitcnt vmcnt(0)
    s_barrier
    ds_read_b64_tr_b16 v[8:9], v4 offset:0
    ds_read_b64_tr_b16 v[10:11], v4 offset:18432
    ds_read_b64_tr_b16 v[12:13], v4 offset:1024
    ds_read_b64_tr_b16 v[14:15], v4 offset:19456
    ds_read_b64_tr_b16 v[16:17], v4 offset:2048
    ds_read_b64_tr_b16 v[18:19], v4 offset:20480
    ds_read_b64_tr_b16 v[20:21], v4 offset:3072
    ds_read_b64_tr_b16 v[22:23], v4 offset:21504
    ds_read_b64_tr_b16 v[24:25], v4 offset:4096
    ds_read_b64_tr_b16 v[26:27], v4 offset:22528
    ds_read_b64_tr_b16 v[28:29], v4 offset:5120
    ds_read_b64_tr_b16 v[30:31], v4 offset:23552
    ds_read_b64_tr_b16 v[32:33], v4 offset:6144
    ds_read_b64_tr_b16 v[34:35], v4 offset:24576
    ds_read_b64_tr_b16 v[36:37], v4 offset:7168
    ds_read_b64_tr_b16 v[38:39], v4 offset:25600
    ds_read_b64_tr_b16 v[40:41], v4 offset:8192
    ds_read_b64_tr_b16 v[42:43], v4 offset:26624
    s_waitcnt lgkmcnt(15)
    buffer_store_dwordx4 v[8:11], v7, s[28:31], s43 offen
    s_add_u32 s43, s43, s44
    s_waitcnt lgkmcnt(14)
    buffer_store_dwordx4 v[12:15], v7, s[28:31], s43 offen
    s_add_u32 s43, s43, s44
    s_waitcnt lgkmcnt(12)
    buffer_store_dwordx4 v[16:19], v7, s[28:31], s43 offen
    s_add_u32 s43, s43, s44
    s_waitcnt lgkmcnt(10)
    buffer_store_dwordx4 v[20:23], v7, s[28:31], s43 offen
    s_add_u32 s43, s43, s44
    s_waitcnt lgkmcnt(8)
    buffer_store_dwordx4 v[24:27], v7, s[28:31], s43 offen
    s_add_u32 s43, s43, s44
    s_waitcnt lgkmcnt(6)
    buffer_store_dwordx4 v[28:31], v7, s[28:31], s43 offen
    s_add_u32 s43, s43, s44
    s_waitcnt lgkmcnt(4)
    buffer_store_dwordx4 v[32:35], v7, s[28:31], s43 offen
    s_add_u32 s43, s43, s44
    s_waitcnt lgkmcnt(2)
    buffer_store_dwordx4 v[36:39], v7, s[28:31], s43 offen
    s_add_u32 s43, s43, s44
    s_waitcnt lgkmcnt(0)
    buffer_store_dwordx4 v[40:43], v7, s[28:31], s43 offen
    s_add_u32 s43, s43, s44
    s_cmp_eq_u32 s47, 1
    s_cbranch_scc0 k0_kernel_Tend
    v_mov_b32 v60, 0x3f803f80
    v_mov_b32 v64, 0
    v_mov_b32 v65, 0
    v_mov_b32 v66, 0
    v_mov_b32 v67, 0
    v_mov_b32 v68, 0
    v_mov_b32 v69, 0
    v_mov_b32 v70, 0
    v_mov_b32 v71, 0
    v_mov_b32 v72, 0
    v_dot2_f32_bf16 v64, v8, v60, v64
    v_dot2_f32_bf16 v65, v12, v60, v65
    v_dot2_f32_bf16 v66, v16, v60, v66
    v_dot2_f32_bf16 v67, v20, v60, v67
    v_dot2_f32_bf16 v68, v24, v60, v68
    v_dot2_f32_bf16 v69, v28, v60, v69
    v_dot2_f32_bf16 v70, v32, v60, v70
    v_dot2_f32_bf16 v71, v36, v60, v71
    v_dot2_f32_bf16 v72, v40, v60, v72
    v_dot2_f32_bf16 v64, v9, v60, v64
    v_dot2_f32_bf16 v65, v13, v60, v65
    v_dot2_f32_bf16 v66, v17, v60, v66
    v_dot2_f32_bf16 v67, v21, v60, v67
    v_dot2_f32_bf16 v68, v25, v60, v68
    v_dot2_f32_bf16 v69, v29, v60, v69
    v_dot2_f32_bf16 v70, v33, v60, v70
    v_dot2_f32_bf16 v71, v37, v60, v71
    v_dot2_f32_bf16 v72, v41, v60, v72
    v_dot2_f32_bf16 v64, v10, v60, v64
    v_dot2_f32_bf16 v65, v14, v60, v65
    v_dot2_f32_bf16 v66, v18, v60, v66
    v_dot2_f32_bf16 v67, v22, v60, v67
    v_dot2_f32_bf16 v68, v26, v60, v68
    v_dot2_f32_bf16 v69, v30, v60, v69
    v_dot2_f32_bf16 v70, v34, v60, v70
    v_dot2_f32_bf16 v71, v38, v60, v71
    v_dot2_f32_bf16 v72, v42, v60, v72
    v_dot2_f32_bf16 v64, v11, v60, v64
    v_dot2_f32_bf16 v65, v15, v60, v65
    v_dot2_f32_bf16 v66, v19, v60, v66
    v_dot2_f32_bf16 v67, v23, v60, v67
    v_dot2_f32_bf16 v68, v27, v60, v68
    v_dot2_f32_bf16 v69, v31, v60, v69
    v_dot2_f32_bf16 v70, v35, v60, v70
    v_dot2_f32_bf16 v71, v39, v60, v71
    v_dot2_f32_bf16 v72, v43, v60, v72
    s_nop 1
    v_mov_b32 v61, v64
    s_nop 1
    v_permlane16_swap_b32 v64, v61
    v_add_f32 v64, v64, v61
    v_mov_b32 v61, v64
    s_nop 1
    v_permlane32_swap_b32 v64, v61
    v_add_f32 v64, v64, v61
    v_mov_b32 v61, v65
    s_nop 1
    v_permlane16_swap_b32 v65, v61
    v_add_f32 v65, v65, v61
    v_mov_b32 v61, v65
    s_nop 1
    v_permlane32_swap_b32 v65, v61
    v_add_f32 v65, v65, v61
    v_mov_b32 v61, v66
    s_nop 1
    v_permlane16_swap_b32 v66, v61
    v_add_f32 v66, v66, v61
    v_mov_b32 v61, v66
    s_nop 1
    v_permlane32_swap_b32 v66, v61
    v_add_f32 v66, v66, v61
    v_mov_b32 v61, v67
    s_nop 1
    v_permlane16_swap_b32 v67, v61
    v_add_f32 v67, v67, v61
    v_mov_b32 v61, v67
    s_nop 1
    v_permlane32_swap_b32 v67, v61
    v_add_f32 v67, v67, v61
    v_mov_b32 v61, v68
    s_nop 1
    v_permlane16_swap_b32 v68, v61
    v_add_f32 v68, v68, v61
    v_mov_b32 v61, v68
    s_nop 1
    v_permlane32_swap_b32 v68, v61
    v_add_f32 v68, v68, v61
    v_mov_b32 v61, v69
    s_nop 1
    v_permlane16_swap_b32 v69, v61
    v_add_f32 v69, v69, v61
    v_mov_b32 v61, v69
    s_nop 1
    v_permlane32_swap_b32 v69, v61
    v_add_f32 v69, v69, v61
    v_mov_b32 v61, v70
    s_nop 1
    v_permlane16_swap_b32 v70, v61
    v_add_f32 v70, v70, v61
    v_mov_b32 v61, v70
    s_nop 1
    v_permlane32_swap_b32 v70, v61
    v_add_f32 v70, v70, v61
    v_mov_b32 v61, v71
    s_nop 1
    v_permlane16_swap_b32 v71, v61
    v_add_f32 v71, v71, v61
    v_mov_b32 v61, v71
    s_nop 1
    v_permlane32_swap_b32 v71, v61
    v_add_f32 v71, v71, v61
    v_mov_b32 v61, v72
    s_nop 1
    v_permlane16_swap_b32 v72, v61
    v_add_f32 v72, v72, v61
    v_mov_b32 v61, v72
    s_nop 1
    v_permlane32_swap_b32 v72, v61
    v_add_f32 v72, v72, v61
    v_and_b32 v62, 15, v1
    v_lshlrev_b32 v62, 2, v62
    s_lshl_b32 s45, s36, 6
    s_add_u32 s46, s46, s45
    s_mov_b64 exec, 0xffff
    buffer_store_dword v64, v62, s[48:51], s46 offen offset:0
    buffer_store_dword v65, v62, s[48:51], s46 offen offset:256
    buffer_store_dword v66, v62, s[48:51], s46 offen offset:512
    buffer_store_dword v67, v62, s[48:51], s46 offen offset:768
    buffer_store_dword v68, v62, s[48:51], s46 offen offset:1024
    buffer_store_dword v69, v62, s[48:51], s46 offen offset:1280
    buffer_store_dword v70, v62, s[48:51], s46 offen offset:1536
    buffer_store_dword v71, v62, s[48:51], s46 offen offset:1792
    buffer_store_dword v72, v62, s[48:51], s46 offen offset:2048
k0_kernel_Tend:
    s_endpgm
k0_kernel_H:
    s_add_u32 s28, s22, 0xd7ba000
    s_addc_u32 s29, s23, 0
    s_mov_b32 s30, 0x180000
    s_mov_b32 s31, 0x00020000
    s_sub_u32 s37, s2, 338
    s_cmp_lg_u32 s37, 0
    s_cbranch_scc1 k0_kernel_H2
    s_add_u32 s24, s22, 0xde4b000
    s_addc_u32 s25, s23, 0
    s_mov_b32 s26, 0x2000
    s_mov_b32 s27, 0x00020000
    v_mov_b32 v12, 0
    v_mov_b32 v13, 0
    v_mov_b32 v14, 0
    v_mov_b32 v15, 0
    v_lshlrev_b32 v3, 4, v0
    buffer_store_dwordx4 v[12:15], v3, s[24:27], 0 offen
    v_add_u32 v3, 4096, v3
    buffer_store_dwordx4 v[12:15], v3, s[24:27], 0 offen
k0_kernel_H2:
    s_lshl_b32 s37, s37, 16
    v_mov_b32 v8, -1
    v_mov_b32 v9, -1
    v_mov_b32 v10, -1
    v_mov_b32 v11, -1
    v_lshlrev_b32 v2, 4, v0
    buffer_store_dwordx4 v[8:11], v2, s[28:31], s37 offen
    s_add_u32 s37, s37, 4096
    buffer_store_dwordx4 v[8:11], v2, s[28:31], s37 offen
    s_add_u32 s37, s37, 4096
    buffer_store_dwordx4 v[8:11], v2, s[28:31], s37 offen
    s_add_u32 s37, s37, 4096
    buffer_store_dwordx4 v[8:11], v2, s[28:31], s37 offen
    s_add_u32 s37, s37, 4096
    buffer_store_dwordx4 v[8:11], v2, s[28:31], s37 offen
    s_add_u32 s37, s37, 4096
    buffer_store_dwordx4 v[8:11], v2, s[28:31], s37 offen
    s_add_u32 s37, s37, 4096
    buffer_store_dwordx4 v[8:11], v2, s[28:31], s37 offen
    s_add_u32 s37, s37, 4096
    buffer_store_dwordx4 v[8:11], v2, s[28:31], s37 offen
    s_add_u32 s37, s37, 4096
    buffer_store_dwordx4 v[8:11], v2, s[28:31], s37 offen
    s_add_u32 s37, s37, 4096
    buffer_store_dwordx4 v[8:11], v2, s[28:31], s37 offen
    s_add_u32 s37, s37, 4096
    buffer_store_dwordx4 v[8:11], v2, s[28:31], s37 offen
    s_add_u32 s37, s37, 4096
    buffer_store_dwordx4 v[8:11], v2, s[28:31], s37 offen
    s_add_u32 s37, s37, 4096
    buffer_store_dwordx4 v[8:11], v2, s[28:31], s37 offen
    s_add_u32 s37, s37, 4096
    buffer_store_dwordx4 v[8:11], v2, s[28:31], s37 offen
    s_add_u32 s37, s37, 4096
    buffer_store_dwordx4 v[8:11], v2, s[28:31], s37 offen
    s_add_u32 s37, s37, 4096
    buffer_store_dwordx4 v[8:11], v2, s[28:31], s37 offen
    s_add_u32 s37, s37, 4096
    s_endpgm
k0_kernel_done:
    s_endpgm

.globl k1_kernel
.p2align 8
.type k1_kernel,@function
k1_kernel:
    s_cmp_ge_u32 s2, 256
    s_cbranch_scc1 k1_kernel_done
    s_load_dwordx2 s[4:5], s[0:1], 88
    s_load_dwordx2 s[6:7], s[0:1], 40
    s_load_dwordx2 s[54:55], s[0:1], 56
    v_lshrrev_b32 v2, 6, v0
    v_and_b32 v1, 63, v0
    v_readfirstlane_b32 s28, v2
    s_and_b32 s31, s2, 7
    s_lshr_b32 s32, s2, 3
    s_and_b32 s30, s31, 1
    s_lshl_b32 s30, s30, 2
    s_and_b32 s33, s32, 3
    s_add_u32 s30, s30, s33
    s_lshr_b32 s56, s32, 2
    s_lshr_b32 s29, s31, 1
    s_lshl_b32 s29, s29, 3
    s_add_u32 s29, s29, s56
    v_lshlrev_b32 v2, 4, v1
    s_waitcnt lgkmcnt(0)
    s_add_u32 s12, s4, 0xca40000
    s_addc_u32 s13, s5, 0
    s_mov_b32 s14, 0x240000
    s_mov_b32 s15, 0x00020000
    s_mov_b32 s40, 0
    s_mov_b32 s41, 4096
    s_mov_b32 s42, 8192
    s_mov_b32 s43, 12288
    s_mov_b32 s44, 16384
    s_mov_b32 s45, 20480
    s_mov_b32 s46, 24576
    s_mov_b32 s47, 28672
    s_mov_b32 s48, 32768
    s_lshl_b32 s52, s28, 10
    s_mul_i32 s39, s29, 73728
    s_add_u32 s49, s39, s52
    s_lshl_b32 s39, s40, 1
    s_add_u32 m0, s52, s39
    s_add_u32 s39, s49, s39
    buffer_load_dwordx4 v2, s[12:15], s39 offen lds
    s_lshl_b32 s39, s41, 1
    s_add_u32 m0, s52, s39
    s_add_u32 s39, s49, s39
    buffer_load_dwordx4 v2, s[12:15], s39 offen lds
    s_lshl_b32 s39, s42, 1
    s_add_u32 m0, s52, s39
    s_add_u32 s39, s49, s39
    buffer_load_dwordx4 v2, s[12:15], s39 offen lds
    s_add_u32 s16, s4, 0xcc80000
    s_addc_u32 s17, s5, 0
    s_mov_b32 s18, 0x30000
    s_mov_b32 s19, 0x00020000
    s_add_u32 s8, s4, 0xc800000
    s_addc_u32 s9, s5, 0
    s_mov_b32 s10, 0x240000
    s_mov_b32 s11, 0x00020000
    s_lshl_b32 s35, s30, 3
    s_add_u32 s35, s35, s28
    s_mul_i32 s36, s35, 36864
    s_add_u32 s37, s36, s40
    buffer_load_dwordx4 v[112:115], v2, s[8:11], s37 offen offset:0
    buffer_load_dwordx4 v[116:119], v2, s[8:11], s37 offen offset:1024
    buffer_load_dwordx4 v[120:123], v2, s[8:11], s37 offen offset:2048
    v_and_b32 v3, 31, v1
    s_lshl_b32 s38, s28, 5
    v_add_u32 v3, s38, v3
    v_mul_u32_u24 v5, 144, v3
    v_add_u32 v5, 73728, v5
    v_lshrrev_b32 v4, 5, v1
    v_mov_b32 v6, 0x3f80
    ds_write_b32 v5, v6 offset:120
    s_add_u32 s20, s4, 0xd7ba000
    s_addc_u32 s21, s5, 0
    s_mov_b32 s22, 0x180000
    s_mov_b32 s23, 0x00020000
    s_add_u32 s24, s4, 0xd93a000
    s_addc_u32 s25, s5, 0
    s_mov_b32 s26, 0x240000
    s_mov_b32 s27, 0x00020000
    s_cmp_lt_u32 s2, 144
    s_cselect_b32 s65, 1, 0
    s_cselect_b32 s60, s6, s54
    s_cselect_b32 s61, s7, s55
    s_mov_b32 s62, 5308416
    s_mov_b32 s63, 0x00020000
    s_cselect_b32 s33, 0, 144
    s_sub_u32 s33, s2, s33
    s_mul_i32 s34, s33, 3641
    s_lshr_b32 s34, s34, 16
    s_mul_i32 s35, s34, 18
    s_sub_u32 s35, s33, s35
    s_cmp_eq_u32 s65, 1
    s_cbranch_scc0 k1_kernel_tw2
    s_mul_i32 s57, s35, 294912
    s_mul_i32 s39, s34, 1152
    s_add_u32 s57, s57, s39
    s_mov_b32 s58, 9216
    s_mul_i32 s59, s34, 684
    s_add_u32 s59, s59, s35
    s_add_u32 s59, s59, 1
    s_mov_b32 s64, 19
    s_branch k1_kernel_tw
k1_kernel_tw2:
    s_mul_i32 s57, s33, 36864
    s_mov_b32 s58, 1152
    s_mul_i32 s59, s34, 648
    s_add_u32 s59, s59, s35
    s_add_u32 s59, s59, 5472
    s_mov_b32 s64, 18
k1_kernel_tw:
    s_mul_i32 s53, s35, 4608
    s_mul_i32 s39, s34, 576
    s_add_u32 s53, s53, s39
    s_lshl_b32 s53, s53, 2
    s_waitcnt vmcnt(3)
    s_barrier
    s_lshl_b32 s39, s40, 1
    v_add_u32 v7, s39, v2
    ds_read_b128 v[24:27], v7 offset:0
    ds_read_b128 v[28:31], v7 offset:1024
    s_lshl_b32 s39, s43, 1
    s_add_u32 m0, s52, s39
    s_add_u32 s39, s49, s39
    buffer_load_dwordx4 v2, s[12:15], s39 offen lds
    s_lshl_b32 s39, s44, 1
    s_add_u32 m0, s52, s39
    s_add_u32 s39, s49, s39
    buffer_load_dwordx4 v2, s[12:15], s39 offen lds
    s_lshl_b32 s39, s45, 1
    s_add_u32 m0, s52, s39
    s_add_u32 s39, s49, s39
    buffer_load_dwordx4 v2, s[12:15], s39 offen lds
    s_lshl_b32 s39, s46, 1
    s_add_u32 m0, s52, s39
    s_add_u32 s39, s49, s39
    buffer_load_dwordx4 v2, s[12:15], s39 offen lds
    s_lshl_b32 s39, s47, 1
    s_add_u32 m0, s52, s39
    s_add_u32 s39, s49, s39
    buffer_load_dwordx4 v2, s[12:15], s39 offen lds
    s_lshl_b32 s39, s48, 1
    s_add_u32 m0, s52, s39
    s_add_u32 s39, s49, s39
    buffer_load_dwordx4 v2, s[12:15], s39 offen lds
    s_min_u32 s33, s28, 5
    s_lshl_b32 s33, s33, 10
    s_mul_i32 s34, s29, 6144
    s_add_u32 s34, s34, s33
    s_add_u32 m0, s33, 150528
    s_nop 0
    buffer_load_dwordx4 v2, s[16:19], s34 offen lds
    buffer_load_dwordx4 v[124:127], v2, s[8:11], s37 offen offset:3072
    s_add_u32 s37, s36, s41
    buffer_load_dwordx4 v[128:131], v2, s[8:11], s37 offen offset:0
    buffer_load_dwordx4 v[132:135], v2, s[8:11], s37 offen offset:1024
    buffer_load_dwordx4 v[136:139], v2, s[8:11], s37 offen offset:2048
    buffer_load_dwordx4 v[140:143], v2, s[8:11], s37 offen offset:3072
    s_add_u32 s37, s36, s42
    buffer_load_dwordx4 v[144:147], v2, s[8:11], s37 offen offset:0
    ds_read_b128 v[32:35], v7 offset:2048
    ds_read_b128 v[36:39], v7 offset:3072
    s_waitcnt vmcnt(15) lgkmcnt(2)
    v_mfma_f32_32x32x16_bf16 v[56:71], v[24:27], v[112:115], 0
    v_mfma_f32_32x32x16_bf16 v[72:87], v[28:31], v[112:115], 0
    buffer_load_dwordx4 v[148:151], v2, s[8:11], s37 offen offset:1024
    ds_read_b128 v[24:27], v7 offset:4096
    ds_read_b128 v[28:31], v7 offset:5120
    s_waitcnt vmcnt(15) lgkmcnt(2)
    v_mfma_f32_32x32x16_bf16 v[56:71], v[32:35], v[116:119], v[56:71]
    v_mfma_f32_32x32x16_bf16 v[72:87], v[36:39], v[116:119], v[72:87]
    buffer_load_dwordx4 v[152:155], v2, s[8:11], s37 offen offset:2048
    ds_read_b128 v[32:35], v7 offset:6144
    ds_read_b128 v[36:39], v7 offset:7168
    s_waitcnt vmcnt(15) lgkmcnt(2)
    v_mfma_f32_32x32x16_bf16 v[56:71], v[24:27], v[120:123], v[56:71]
    v_mfma_f32_32x32x16_bf16 v[72:87], v[28:31], v[120:123], v[72:87]
    buffer_load_dwordx4 v[156:159], v2, s[8:11], s37 offen offset:3072
    s_lshl_b32 s39, s41, 1
    v_add_u32 v8, s39, v2
    ds_read_b128 v[24:27], v8 offset:0
    ds_read_b128 v[28:31], v8 offset:1024
    s_waitcnt vmcnt(8) lgkmcnt(2)
    v_mfma_f32_32x32x16_bf16 v[56:71], v[32:35], v[124:127], v[56:71]
    v_mfma_f32_32x32x16_bf16 v[72:87], v[36:39], v[124:127], v[72:87]
    s_add_u32 s37, s36, s43
    buffer_load_dwordx4 v[160:163], v2, s[8:11], s37 offen offset:0
    ds_read_b128 v[32:35], v8 offset:2048
    ds_read_b128 v[36:39], v8 offset:3072
    s_waitcnt vmcnt(8) lgkmcnt(2)
    v_mfma_f32_32x32x16_bf16 v[56:71], v[24:27], v[128:131], v[56:71]
    v_mfma_f32_32x32x16_bf16 v[72:87], v[28:31], v[128:131], v[72:87]
    buffer_load_dwordx4 v[164:167], v2, s[8:11], s37 offen offset:1024
    ds_read_b128 v[24:27], v8 offset:4096
    ds_read_b128 v[28:31], v8 offset:5120
    s_waitcnt vmcnt(8) lgkmcnt(2)
    v_mfma_f32_32x32x16_bf16 v[56:71], v[32:35], v[132:135], v[56:71]
    v_mfma_f32_32x32x16_bf16 v[72:87], v[36:39], v[132:135], v[72:87]
    buffer_load_dwordx4 v[168:171], v2, s[8:11], s37 offen offset:2048
    ds_read_b128 v[32:35], v8 offset:6144
    ds_read_b128 v[36:39], v8 offset:7168
    s_waitcnt vmcnt(8) lgkmcnt(2)
    v_mfma_f32_32x32x16_bf16 v[56:71], v[24:27], v[136:139], v[56:71]
    v_mfma_f32_32x32x16_bf16 v[72:87], v[28:31], v[136:139], v[72:87]
    buffer_load_dwordx4 v[172:175], v2, s[8:11], s37 offen offset:3072
    s_lshl_b32 s39, s42, 1
    v_add_u32 v7, s39, v2
    ds_read_b128 v[24:27], v7 offset:0
    ds_read_b128 v[28:31], v7 offset:1024
    s_waitcnt vmcnt(8) lgkmcnt(2)
    v_mfma_f32_32x32x16_bf16 v[56:71], v[32:35], v[140:143], v[56:71]
    v_mfma_f32_32x32x16_bf16 v[72:87], v[36:39], v[140:143], v[72:87]
    s_add_u32 s37, s36, s44
    buffer_load_dwordx4 v[176:179], v2, s[8:11], s37 offen offset:0
    ds_read_b128 v[32:35], v7 offset:2048
    ds_read_b128 v[36:39], v7 offset:3072
    s_waitcnt vmcnt(8) lgkmcnt(2)
    v_mfma_f32_32x32x16_bf16 v[56:71], v[24:27], v[144:147], v[56:71]
    v_mfma_f32_32x32x16_bf16 v[72:87], v[28:31], v[144:147], v[72:87]
    buffer_load_dwordx4 v[180:183], v2, s[8:11], s37 offen offset:1024
    ds_read_b128 v[24:27], v7 offset:4096
    ds_read_b128 v[28:31], v7 offset:5120
    s_waitcnt vmcnt(8) lgkmcnt(2)
    v_mfma_f32_32x32x16_bf16 v[56:71], v[32:35], v[148:151], v[56:71]
    v_mfma_f32_32x32x16_bf16 v[72:87], v[36:39], v[148:151], v[72:87]
    buffer_load_dwordx4 v[184:187], v2, s[8:11], s37 offen offset:2048
    ds_read_b128 v[32:35], v7 offset:6144
    ds_read_b128 v[36:39], v7 offset:7168
    s_waitcnt vmcnt(8) lgkmcnt(2)
    v_mfma_f32_32x32x16_bf16 v[56:71], v[24:27], v[152:155], v[56:71]
    v_mfma_f32_32x32x16_bf16 v[72:87], v[28:31], v[152:155], v[72:87]
    buffer_load_dwordx4 v[188:191], v2, s[8:11], s37 offen offset:3072
    s_waitcnt vmcnt(17)
    s_barrier
    s_lshl_b32 s39, s43, 1
    v_add_u32 v8, s39, v2
    ds_read_b128 v[24:27], v8 offset:0
    ds_read_b128 v[28:31], v8 offset:1024
    s_waitcnt vmcnt(8) lgkmcnt(2)
    v_mfma_f32_32x32x16_bf16 v[56:71], v[32:35], v[156:159], v[56:71]
    v_mfma_f32_32x32x16_bf16 v[72:87], v[36:39], v[156:159], v[72:87]
    s_add_u32 s37, s36, s45
    buffer_load_dwordx4 v[192:195], v2, s[8:11], s37 offen offset:0
    ds_read_b128 v[32:35], v8 offset:2048
    ds_read_b128 v[36:39], v8 offset:3072
    s_waitcnt vmcnt(8) lgkmcnt(2)
    v_mfma_f32_32x32x16_bf16 v[56:71], v[24:27], v[160:163], v[56:71]
    v_mfma_f32_32x32x16_bf16 v[72:87], v[28:31], v[160:163], v[72:87]
    buffer_load_dwordx4 v[196:199], v2, s[8:11], s37 offen offset:1024
    ds_read_b128 v[24:27], v8 offset:4096
    ds_read_b128 v[28:31], v8 offset:5120
    s_waitcnt vmcnt(8) lgkmcnt(2)
    v_mfma_f32_32x32x16_bf16 v[56:71], v[32:35], v[164:167], v[56:71]
    v_mfma_f32_32x32x16_bf16 v[72:87], v[36:39], v[164:167], v[72:87]
    buffer_load_dwordx4 v[200:203], v2, s[8:11], s37 offen offset:2048
    ds_read_b128 v[32:35], v8 offset:6144
    ds_read_b128 v[36:39], v8 offset:7168
    s_waitcnt vmcnt(8) lgkmcnt(2)
    v_mfma_f32_32x32x16_bf16 v[56:71], v[24:27], v[168:171], v[56:71]
    v_mfma_f32_32x32x16_bf16 v[72:87], v[28:31], v[168:171], v[72:87]
    buffer_load_dwordx4 v[204:207], v2, s[8:11], s37 offen offset:3072
    s_lshl_b32 s39, s44, 1
    v_add_u32 v7, s39, v2
    ds_read_b128 v[24:27], v7 offset:0
    ds_read_b128 v[28:31], v7 offset:1024
    s_waitcnt vmcnt(8) lgkmcnt(2)
    v_mfma_f32_32x32x16_bf16 v[56:71], v[32:35], v[172:175], v[56:71]
    v_mfma_f32_32x32x16_bf16 v[72:87], v[36:39], v[172:175], v[72:87]
    s_add_u32 s37, s36, s46
    buffer_load_dwordx4 v[208:211], v2, s[8:11], s37 offen offset:0
    ds_read_b128 v[32:35], v7 offset:2048
    ds_read_b128 v[36:39], v7 offset:3072
    s_waitcnt vmcnt(8) lgkmcnt(2)
    v_mfma_f32_32x32x16_bf16 v[56:71], v[24:27], v[176:179], v[56:71]
    v_mfma_f32_32x32x16_bf16 v[72:87], v[28:31], v[176:179], v[72:87]
    buffer_load_dwordx4 v[212:215], v2, s[8:11], s37 offen offset:1024
    ds_read_b128 v[24:27], v7 offset:4096
    ds_read_b128 v[28:31], v7 offset:5120
    s_waitcnt vmcnt(8) lgkmcnt(2)
    v_mfma_f32_32x32x16_bf16 v[56:71], v[32:35], v[180:183], v[56:71]
    v_mfma_f32_32x32x16_bf16 v[72:87], v[36:39], v[180:183], v[72:87]
    buffer_load_dwordx4 v[216:219], v2, s[8:11], s37 offen offset:2048
    ds_read_b128 v[32:35], v7 offset:6144
    ds_read_b128 v[36:39], v7 offset:7168
    s_waitcnt vmcnt(8) lgkmcnt(2)
    v_mfma_f32_32x32x16_bf16 v[56:71], v[24:27], v[184:187], v[56:71]
    v_mfma_f32_32x32x16_bf16 v[72:87], v[28:31], v[184:187], v[72:87]
    buffer_load_dwordx4 v[220:223], v2, s[8:11], s37 offen offset:3072
    s_lshl_b32 s39, s45, 1
    v_add_u32 v8, s39, v2
    ds_read_b128 v[24:27], v8 offset:0
    ds_read_b128 v[28:31], v8 offset:1024
    s_waitcnt vmcnt(8) lgkmcnt(2)
    v_mfma_f32_32x32x16_bf16 v[56:71], v[32:35], v[188:191], v[56:71]
    v_mfma_f32_32x32x16_bf16 v[72:87], v[36:39], v[188:191], v[72:87]
    s_add_u32 s37, s36, s47
    buffer_load_dwordx4 v[224:227], v2, s[8:11], s37 offen offset:0
    ds_read_b128 v[32:35], v8 offset:2048
    ds_read_b128 v[36:39], v8 offset:3072
    s_waitcnt vmcnt(8) lgkmcnt(2)
    v_mfma_f32_32x32x16_bf16 v[56:71], v[24:27], v[192:195], v[56:71]
    v_mfma_f32_32x32x16_bf16 v[72:87], v[28:31], v[192:195], v[72:87]
    buffer_load_dwordx4 v[228:231], v2, s[8:11], s37 offen offset:1024
    ds_read_b128 v[24:27], v8 offset:4096
    ds_read_b128 v[28:31], v8 offset:5120
    s_waitcnt vmcnt(8) lgkmcnt(2)
    v_mfma_f32_32x32x16_bf16 v[56:71], v[32:35], v[196:199], v[56:71]
    v_mfma_f32_32x32x16_bf16 v[72:87], v[36:39], v[196:199], v[72:87]
    buffer_load_dwordx4 v[232:235], v2, s[8:11], s37 offen offset:2048
    ds_read_b128 v[32:35], v8 offset:6144
    ds_read_b128 v[36:39], v8 offset:7168
    s_waitcnt vmcnt(8) lgkmcnt(2)
    v_mfma_f32_32x32x16_bf16 v[56:71], v[24:27], v[200:203], v[56:71]
    v_mfma_f32_32x32x16_bf16 v[72:87], v[28:31], v[200:203], v[72:87]
    buffer_load_dwordx4 v[236:239], v2, s[8:11], s37 offen offset:3072
    s_lshl_b32 s39, s46, 1
    v_add_u32 v7, s39, v2
    ds_read_b128 v[24:27], v7 offset:0
    ds_read_b128 v[28:31], v7 offset:1024
    s_waitcnt vmcnt(8) lgkmcnt(2)
    v_mfma_f32_32x32x16_bf16 v[56:71], v[32:35], v[204:207], v[56:71]
    v_mfma_f32_32x32x16_bf16 v[72:87], v[36:39], v[204:207], v[72:87]
    s_add_u32 s37, s36, s48
    buffer_load_dwordx4 v[240:243], v2, s[8:11], s37 offen offset:0
    ds_read_b128 v[32:35], v7 offset:2048
    ds_read_b128 v[36:39], v7 offset:3072
    s_waitcnt vmcnt(8) lgkmcnt(2)
    v_mfma_f32_32x32x16_bf16 v[56:71], v[24:27], v[208:211], v[56:71]
    v_mfma_f32_32x32x16_bf16 v[72:87], v[28:31], v[208:211], v[72:87]
    buffer_load_dwordx4 v[244:247], v2, s[8:11], s37 offen offset:1024
    ds_read_b128 v[24:27], v7 offset:4096
    ds_read_b128 v[28:31], v7 offset:5120
    s_waitcnt vmcnt(8) lgkmcnt(2)
    v_mfma_f32_32x32x16_bf16 v[56:71], v[32:35], v[212:215], v[56:71]
    v_mfma_f32_32x32x16_bf16 v[72:87], v[36:39], v[212:215], v[72:87]
    buffer_load_dwordx4 v[248:251], v2, s[8:11], s37 offen offset:2048
    ds_read_b128 v[32:35], v7 offset:6144
    ds_read_b128 v[36:39], v7 offset:7168
    s_waitcnt vmcnt(8) lgkmcnt(2)
    v_mfma_f32_32x32x16_bf16 v[56:71], v[24:27], v[216:219], v[56:71]
    v_mfma_f32_32x32x16_bf16 v[72:87], v[28:31], v[216:219], v[72:87]
    buffer_load_dwordx4 v[252:255], v2, s[8:11], s37 offen offset:3072
    s_lshl_b32 s39, s47, 1
    v_add_u32 v8, s39, v2
    ds_read_b128 v[24:27], v8 offset:0
    ds_read_b128 v[28:31], v8 offset:1024
    s_waitcnt vmcnt(8) lgkmcnt(2)
    v_mfma_f32_32x32x16_bf16 v[56:71], v[32:35], v[220:223], v[56:71]
    v_mfma_f32_32x32x16_bf16 v[72:87], v[36:39], v[220:223], v[72:87]
    ds_read_b128 v[32:35], v8 offset:2048
    ds_read_b128 v[36:39], v8 offset:3072
    s_waitcnt vmcnt(7) lgkmcnt(2)
    v_mfma_f32_32x32x16_bf16 v[56:71], v[24:27], v[224:227], v[56:71]
    v_mfma_f32_32x32x16_bf16 v[72:87], v[28:31], v[224:227], v[72:87]
    ds_read_b128 v[24:27], v8 offset:4096
    ds_read_b128 v[28:31], v8 offset:5120
    s_waitcnt vmcnt(6) lgkmcnt(2)
    v_mfma_f32_32x32x16_bf16 v[56:71], v[32:35], v[228:231], v[56:71]
    v_mfma_f32_32x32x16_bf16 v[72:87], v[36:39], v[228:231], v[72:87]
    ds_read_b128 v[32:35], v8 offset:6144
    ds_read_b128 v[36:39], v8 offset:7168
    s_waitcnt vmcnt(5) lgkmcnt(2)
    v_mfma_f32_32x32x16_bf16 v[56:71], v[24:27], v[232:235], v[56:71]
    v_mfma_f32_32x32x16_bf16 v[72:87], v[28:31], v[232:235], v[72:87]
    s_lshl_b32 s39, s48, 1
    v_add_u32 v7, s39, v2
    ds_read_b128 v[24:27], v7 offset:0
    ds_read_b128 v[28:31], v7 offset:1024
    s_waitcnt vmcnt(4) lgkmcnt(2)
    v_mfma_f32_32x32x16_bf16 v[56:71], v[32:35], v[236:239], v[56:71]
    v_mfma_f32_32x32x16_bf16 v[72:87], v[36:39], v[236:239], v[72:87]
    ds_read_b128 v[32:35], v7 offset:2048
    ds_read_b128 v[36:39], v7 offset:3072
    s_waitcnt vmcnt(3) lgkmcnt(2)
    v_mfma_f32_32x32x16_bf16 v[56:71], v[24:27], v[240:243], v[56:71]
    v_mfma_f32_32x32x16_bf16 v[72:87], v[28:31], v[240:243], v[72:87]
    ds_read_b128 v[24:27], v7 offset:4096
    ds_read_b128 v[28:31], v7 offset:5120
    s_waitcnt vmcnt(2) lgkmcnt(2)
    v_mfma_f32_32x32x16_bf16 v[56:71], v[32:35], v[244:247], v[56:71]
    v_mfma_f32_32x32x16_bf16 v[72:87], v[36:39], v[244:247], v[72:87]
    ds_read_b128 v[32:35], v7 offset:6144
    ds_read_b128 v[36:39], v7 offset:7168
    s_waitcnt vmcnt(1) lgkmcnt(2)
    v_mfma_f32_32x32x16_bf16 v[56:71], v[24:27], v[248:251], v[56:71]
    v_mfma_f32_32x32x16_bf16 v[72:87], v[28:31], v[248:251], v[72:87]
    s_waitcnt vmcnt(0) lgkmcnt(0)
    v_mfma_f32_32x32x16_bf16 v[56:71], v[32:35], v[252:255], v[56:71]
    v_mfma_f32_32x32x16_bf16 v[72:87], v[36:39], v[252:255], v[72:87]
    v_add_u32 v9, 150528, v2
    ds_read_b128 v[88:91], v9 offset:0
    ds_read_b128 v[92:95], v9 offset:1024
    ds_read_b128 v[96:99], v9 offset:2048
    ds_read_b128 v[100:103], v9 offset:3072
    ds_read_b128 v[104:107], v9 offset:4096
    ds_read_b128 v[108:111], v9 offset:5120
    s_nop 4
    v_cvt_pk_bf16_f32 v128, v56, v57
    v_cvt_pk_bf16_f32 v129, v58, v59
    v_cvt_pk_bf16_f32 v130, v60, v61
    v_cvt_pk_bf16_f32 v131, v62, v63
    v_cvt_pk_bf16_f32 v132, v64, v65
    v_cvt_pk_bf16_f32 v133, v66, v67
    v_cvt_pk_bf16_f32 v134, v68, v69
    v_cvt_pk_bf16_f32 v135, v70, v71
    v_cvt_pk_bf16_f32 v136, v72, v73
    v_cvt_pk_bf16_f32 v137, v74, v75
    v_cvt_pk_bf16_f32 v138, v76, v77
    v_cvt_pk_bf16_f32 v139, v78, v79
    v_cvt_pk_bf16_f32 v140, v80, v81
    v_cvt_pk_bf16_f32 v141, v82, v83
    s_waitcnt lgkmcnt(0)
    v_mfma_f32_32x32x16_bf16 v[40:55], v[88:91], v[128:131], 0
    v_mfma_f32_32x32x16_bf16 v[112:127], v[100:103], v[128:131], 0
    v_mfma_f32_32x32x16_bf16 v[40:55], v[92:95], v[132:135], v[40:55]
    v_mfma_f32_32x32x16_bf16 v[112:127], v[104:107], v[132:135], v[112:127]
    v_mfma_f32_32x32x16_bf16 v[40:55], v[96:99], v[136:139], v[40:55]
    v_mfma_f32_32x32x16_bf16 v[112:127], v[108:111], v[136:139], v[112:127]
    v_lshl_add_u32 v8, v4, 3, v5
    ds_write_b64 v8, v[136:137] offset:72
    ds_write_b64 v8, v[138:139] offset:88
    ds_write_b64 v8, v[140:141] offset:104
    s_nop 9
    v_max3_f32 v9, v40, v41, v42
    v_min3_f32 v10, v40, v41, v42
    v_max3_f32 v9, v9, v43, v44
    v_min3_f32 v10, v10, v43, v44
    v_max3_f32 v9, v9, v45, v46
    v_min3_f32 v10, v10, v45, v46
    v_max3_f32 v9, v9, v47, v48
    v_min3_f32 v10, v10, v47, v48
    v_max3_f32 v9, v9, v49, v50
    v_min3_f32 v10, v10, v49, v50
    v_max3_f32 v9, v9, v51, v52
    v_min3_f32 v10, v10, v51, v52
    v_max3_f32 v9, v9, v53, v54
    v_min3_f32 v10, v10, v53, v54
    v_max3_f32 v9, v9, v55, v112
    v_min3_f32 v10, v10, v55, v112
    v_max_f32 v9, v9, v113
    v_min_f32 v10, v10, v113
    s_mov_b32 s39, 0x3fb8aa3b
    v_mul_f32 v9, s39, v9
    v_mul_f32 v10, s39, v10
    v_fma_f32 v144, v40, s39, -v9
    v_fma_f32 v162, -v40, s39, v10
    v_fma_f32 v145, v41, s39, -v9
    v_fma_f32 v163, -v41, s39, v10
    v_fma_f32 v146, v42, s39, -v9
    v_fma_f32 v164, -v42, s39, v10
    v_fma_f32 v147, v43, s39, -v9
    v_fma_f32 v165, -v43, s39, v10
    v_fma_f32 v148, v44, s39, -v9
    v_fma_f32 v166, -v44, s39, v10
    v_fma_f32 v149, v45, s39, -v9
    v_fma_f32 v167, -v45, s39, v10
    v_fma_f32 v150, v46, s39, -v9
    v_fma_f32 v168, -v46, s39, v10
    v_fma_f32 v151, v47, s39, -v9
    v_fma_f32 v169, -v47, s39, v10
    v_fma_f32 v152, v48, s39, -v9
    v_fma_f32 v170, -v48, s39, v10
    v_fma_f32 v153, v49, s39, -v9
    v_fma_f32 v171, -v49, s39, v10
    v_fma_f32 v154, v50, s39, -v9
    v_fma_f32 v172, -v50, s39, v10
    v_fma_f32 v155, v51, s39, -v9
    v_fma_f32 v173, -v51, s39, v10
    v_fma_f32 v156, v52, s39, -v9
    v_fma_f32 v174, -v52, s39, v10
    v_fma_f32 v157, v53, s39, -v9
    v_fma_f32 v175, -v53, s39, v10
    v_fma_f32 v158, v54, s39, -v9
    v_fma_f32 v176, -v54, s39, v10
    v_fma_f32 v159, v55, s39, -v9
    v_fma_f32 v177, -v55, s39, v10
    v_fma_f32 v160, v112, s39, -v9
    v_fma_f32 v178, -v112, s39, v10
    v_fma_f32 v161, v113, s39, -v9
    v_fma_f32 v179, -v113, s39, v10
    v_exp_f32 v144, v144
    v_exp_f32 v145, v145
    v_exp_f32 v146, v146
    v_exp_f32 v147, v147
    v_exp_f32 v148, v148
    v_exp_f32 v149, v149
    v_exp_f32 v150, v150
    v_exp_f32 v151, v151
    v_exp_f32 v152, v152
    v_exp_f32 v153, v153
    v_exp_f32 v154, v154
    v_exp_f32 v155, v155
    v_exp_f32 v156, v156
    v_exp_f32 v157, v157
    v_exp_f32 v158, v158
    v_exp_f32 v159, v159
    v_exp_f32 v160, v160
    v_exp_f32 v161, v161
    v_exp_f32 v162, v162
    v_exp_f32 v163, v163
    v_exp_f32 v164, v164
    v_exp_f32 v165, v165
    v_exp_f32 v166, v166
    v_exp_f32 v167, v167
    v_exp_f32 v168, v168
    v_exp_f32 v169, v169
    v_exp_f32 v170, v170
    v_exp_f32 v171, v171
    v_exp_f32 v172, v172
    v_exp_f32 v173, v173
    v_exp_f32 v174, v174
    v_exp_f32 v175, v175
    v_exp_f32 v176, v176
    v_exp_f32 v177, v177
    v_exp_f32 v178, v178
    v_exp_f32 v179, v179
    s_nop 0
    v_add_f32 v11, v144, v145
    v_add_f32 v12, v162, v163
    v_add_f32 v11, v11, v146
    v_add_f32 v12, v12, v164
    v_add_f32 v11, v11, v147
    v_add_f32 v12, v12, v165
    v_add_f32 v11, v11, v148
    v_add_f32 v12, v12, v166
    v_add_f32 v11, v11, v149
    v_add_f32 v12, v12, v167
    v_add_f32 v11, v11, v150
    v_add_f32 v12, v12, v168
    v_add_f32 v11, v11, v151
    v_add_f32 v12, v12, v169
    v_add_f32 v11, v11, v152
    v_add_f32 v12, v12, v170
    v_add_f32 v11, v11, v153
    v_add_f32 v12, v12, v171
    v_add_f32 v11, v11, v154
    v_add_f32 v12, v12, v172
    v_add_f32 v11, v11, v155
    v_add_f32 v12, v12, v173
    v_add_f32 v11, v11, v156
    v_add_f32 v12, v12, v174
    v_add_f32 v11, v11, v157
    v_add_f32 v12, v12, v175
    v_add_f32 v11, v11, v158
    v_add_f32 v12, v12, v176
    v_add_f32 v11, v11, v159
    v_add_f32 v12, v12, v177
    v_add_f32 v11, v11, v160
    v_add_f32 v12, v12, v178
    v_add_f32 v11, v11, v161
    v_add_f32 v12, v12, v179
    v_rcp_f32 v11, v11
    v_rcp_f32 v12, v12
    s_nop 0
    v_mul_f32 v144, v11, v144
    v_mul_f32 v162, v12, v162
    v_mul_f32 v145, v11, v145
    v_mul_f32 v163, v12, v163
    v_mul_f32 v146, v11, v146
    v_mul_f32 v164, v12, v164
    v_mul_f32 v147, v11, v147
    v_mul_f32 v165, v12, v165
    v_mul_f32 v148, v11, v148
    v_mul_f32 v166, v12, v166
    v_mul_f32 v149, v11, v149
    v_mul_f32 v167, v12, v167
    v_mul_f32 v150, v11, v150
    v_mul_f32 v168, v12, v168
    v_mul_f32 v151, v11, v151
    v_mul_f32 v169, v12, v169
    v_mul_f32 v152, v11, v152
    v_mul_f32 v170, v12, v170
    v_mul_f32 v153, v11, v153
    v_mul_f32 v171, v12, v171
    v_mul_f32 v154, v11, v154
    v_mul_f32 v172, v12, v172
    v_mul_f32 v155, v11, v155
    v_mul_f32 v173, v12, v173
    v_mul_f32 v156, v11, v156
    v_mul_f32 v174, v12, v174
    v_mul_f32 v157, v11, v157
    v_mul_f32 v175, v12, v175
    v_mul_f32 v158, v11, v158
    v_mul_f32 v176, v12, v176
    v_mul_f32 v159, v11, v159
    v_mul_f32 v177, v12, v177
    v_mul_f32 v160, v11, v160
    v_mul_f32 v178, v12, v178
    v_mul_f32 v161, v11, v161
    v_mul_f32 v179, v12, v179
    v_cvt_pk_bf16_f32 v180, v144, v145
    v_cvt_pk_bf16_f32 v181, v146, v147
    v_cvt_pk_bf16_f32 v182, v148, v149
    v_cvt_pk_bf16_f32 v183, v150, v151
    v_cvt_pk_bf16_f32 v184, v152, v153
    v_cvt_pk_bf16_f32 v185, v154, v155
    v_cvt_pk_bf16_f32 v186, v156, v157
    v_cvt_pk_bf16_f32 v187, v158, v159
    v_cvt_pk_bf16_f32 v188, v160, v161
    v_cvt_pk_bf16_f32 v189, v162, v163
    v_cvt_pk_bf16_f32 v190, v164, v165
    v_cvt_pk_bf16_f32 v191, v166, v167
    v_cvt_pk_bf16_f32 v192, v168, v169
    v_cvt_pk_bf16_f32 v193, v170, v171
    v_cvt_pk_bf16_f32 v194, v172, v173
    v_cvt_pk_bf16_f32 v195, v174, v175
    v_cvt_pk_bf16_f32 v196, v176, v177
    v_cvt_pk_bf16_f32 v197, v178, v179
    s_mov_b64 s[50:51], exec
    s_mov_b32 exec_lo, 0
    ds_write_b64 v5, v[196:197] offset:64
    s_mov_b64 exec, s[50:51]
    s_nop 1
    v_permlane32_swap_b32 v180, v184
    v_permlane32_swap_b32 v181, v185
    v_permlane32_swap_b32 v182, v186
    v_permlane32_swap_b32 v183, v187
    v_permlane32_swap_b32 v188, v192
    v_permlane32_swap_b32 v189, v193
    v_permlane32_swap_b32 v190, v194
    v_permlane32_swap_b32 v191, v195
    v_lshl_add_u32 v8, v4, 4, v5
    ds_write_b128 v8, v[184:187]
    ds_write_b128 v8, v[192:195] offset:32
    v_cmp_gt_u32 vcc, 32, v1
    s_nop 1
    v_cndmask_b32 v196, 0, v196, vcc
    v_cndmask_b32 v197, 0, v197, vcc
    v_mov_b32 v198, 0
    v_mov_b32 v199, 0
    v_lshrrev_b32 v23, 3, v1
    v_mul_lo_u32 v23, v23, s58
    v_and_b32 v22, 7, v1
    v_lshl_add_u32 v23, v22, 4, v23
    s_lshl_b32 s33, s58, 3
    s_lshl_b32 s34, s28, 7
    s_add_u32 s34, s34, s57
    s_lshl_b32 s35, s28, 12
    s_add_u32 s35, s35, 113664
    s_add_u32 m0, s35, 0
    s_nop 0
    buffer_load_dwordx4 v23, s[60:63], s34 offen  lds
    s_add_u32 s34, s34, s33
    s_add_u32 m0, s35, 1024
    s_nop 0
    buffer_load_dwordx4 v23, s[60:63], s34 offen  lds
    s_add_u32 s34, s34, s33
    s_add_u32 m0, s35, 2048
    s_nop 0
    buffer_load_dwordx4 v23, s[60:63], s34 offen  lds
    s_add_u32 s34, s34, s33
    s_add_u32 m0, s35, 3072
    s_nop 0
    buffer_load_dwordx4 v23, s[60:63], s34 offen  lds
    s_cmp_lg_u32 s28, 7
    s_cbranch_scc1 k1_kernel_nodma5
    s_lshl_b32 s34, 8, 7
    s_add_u32 s34, s34, s57
    s_add_u32 m0, 146432, 0
    s_nop 0
    buffer_load_dwordx4 v23, s[60:63], s34 offen  lds
    s_add_u32 s34, s34, s33
    s_add_u32 m0, 147456, 0
    s_nop 0
    buffer_load_dwordx4 v23, s[60:63], s34 offen  lds
    s_add_u32 s34, s34, s33
    s_add_u32 m0, 148480, 0
    s_nop 0
    buffer_load_dwordx4 v23, s[60:63], s34 offen  lds
    s_add_u32 s34, s34, s33
    s_add_u32 m0, 149504, 0
    s_nop 0
    buffer_load_dwordx4 v23, s[60:63], s34 offen  lds
k1_kernel_nodma5:
    s_waitcnt lgkmcnt(0)
    s_barrier
    s_cmp_ge_u32 s28, 6
    s_cbranch_scc1 k1_kernel_skipkv1
    s_lshr_b32 s40, s28, 1
    s_and_b32 s41, s28, 1
    v_lshrrev_b32 v9, 4, v1
    v_bfe_u32 v10, v1, 2, 2
    v_lshl_add_u32 v10, v9, 3, v10
    v_mul_u32_u24 v10, 144, v10
    v_and_b32 v11, 3, v1
    v_lshl_add_u32 v10, v11, 3, v10
    v_add_u32 v10, 73728, v10
    s_lshl_b32 s42, s40, 5
    v_add_u32 v11, s42, v10
    s_lshl_b32 s42, s41, 5
    s_add_u32 s42, s42, 80
    v_add_u32 v12, s42, v10
    ds_read_b64_tr_b16 v[112:113], v11 offset:0
    ds_read_b64_tr_b16 v[114:115], v11 offset:576
    ds_read_b64_tr_b16 v[116:117], v12 offset:0
    ds_read_b64_tr_b16 v[118:119], v12 offset:576
    ds_read_b64_tr_b16 v[120:121], v11 offset:4608
    ds_read_b64_tr_b16 v[122:123], v11 offset:5184
    ds_read_b64_tr_b16 v[124:125], v12 offset:4608
    ds_read_b64_tr_b16 v[126:127], v12 offset:5184
    ds_read_b64_tr_b16 v[128:129], v11 offset:9216
    ds_read_b64_tr_b16 v[130:131], v11 offset:9792
    ds_read_b64_tr_b16 v[132:133], v12 offset:9216
    ds_read_b64_tr_b16 v[134:135], v12 offset:9792
    ds_read_b64_tr_b16 v[136:137], v11 offset:13824
    ds_read_b64_tr_b16 v[138:139], v11 offset:14400
    ds_read_b64_tr_b16 v[140:141], v12 offset:13824
    ds_read_b64_tr_b16 v[142:143], v12 offset:14400
    ds_read_b64_tr_b16 v[144:145], v11 offset:18432
    ds_read_b64_tr_b16 v[146:147], v11 offset:19008
    ds_read_b64_tr_b16 v[148:149], v12 offset:18432
    ds_read_b64_tr_b16 v[150:151], v12 offset:19008
    ds_read_b64_tr_b16 v[152:153], v11 offset:23040
    ds_read_b64_tr_b16 v[154:155], v11 offset:23616
    ds_read_b64_tr_b16 v[156:157], v12 offset:23040
    ds_read_b64_tr_b16 v[158:159], v12 offset:23616
    ds_read_b64_tr_b16 v[160:161], v11 offset:27648
    ds_read_b64_tr_b16 v[162:163], v11 offset:28224
    ds_read_b64_tr_b16 v[164:165], v12 offset:27648
    ds_read_b64_tr_b16 v[166:167], v12 offset:28224
    ds_read_b64_tr_b16 v[168:169], v11 offset:32256
    ds_read_b64_tr_b16 v[170:171], v11 offset:32832
    ds_read_b64_tr_b16 v[172:173], v12 offset:32256
    ds_read_b64_tr_b16 v[174:175], v12 offset:32832
    s_waitcnt lgkmcnt(15)
    v_mfma_f32_16x16x32_bf16 v[40:43], v[112:115], v[116:119], 0
    s_waitcnt lgkmcnt(15)
    v_mfma_f32_16x16x32_bf16 v[40:43], v[120:123], v[124:127], v[40:43]
    s_waitcnt lgkmcnt(15)
    v_mfma_f32_16x16x32_bf16 v[40:43], v[128:131], v[132:135], v[40:43]
    s_waitcnt lgkmcnt(15)
    v_mfma_f32_16x16x32_bf16 v[40:43], v[136:139], v[140:143], v[40:43]
    s_waitcnt lgkmcnt(12)
    v_mfma_f32_16x16x32_bf16 v[40:43], v[144:147], v[148:151], v[40:43]
    s_waitcnt lgkmcnt(8)
    v_mfma_f32_16x16x32_bf16 v[40:43], v[152:155], v[156:159], v[40:43]
    s_waitcnt lgkmcnt(4)
    v_mfma_f32_16x16x32_bf16 v[40:43], v[160:163], v[164:167], v[40:43]
    s_waitcnt lgkmcnt(0)
    v_mfma_f32_16x16x32_bf16 v[40:43], v[168:171], v[172:175], v[40:43]
    v_and_b32 v13, 15, v1
    s_mov_b64 s[44:45], -1
    s_cmp_eq_u32 s41, 0
    s_cbranch_scc1 k1_kernel_m1
    s_mov_b32 s44, 0x00130013
    s_mov_b32 s45, 0x00130013
k1_kernel_m1:
    s_mov_b64 s[42:43], s[44:45]
    s_cmp_lt_u32 s40, 2
    s_cbranch_scc1 k1_kernel_m2
    s_and_b32 s42, s42, 0xffff
    s_mov_b32 s43, 0
k1_kernel_m2:
    s_lshl_b32 s46, s29, 3
    s_add_u32 s47, s46, s30
    s_mul_i32 s47, s47, 6
    s_add_u32 s47, s47, s28
    s_lshl_b32 s47, s47, 10
    s_mul_i32 s46, s46, 6
    s_add_u32 s46, s46, s28
    s_lshl_b32 s46, s46, 10
    s_mov_b64 s[50:51], exec
    s_mov_b64 exec, s[42:43]
    s_nop 2
    buffer_store_dwordx4 v[40:43], v2, s[20:23], s47 offen sc1
    s_mov_b64 exec, s[50:51]
    s_waitcnt vmcnt(1)
    s_branch k1_kernel_tstart
k1_kernel_skipkv1:
    s_waitcnt vmcnt(0)
k1_kernel_tstart:
    s_add_u32 s8, s4, 0xcd52000
    s_addc_u32 s9, s5, 0
    s_mov_b32 s10, 0xa68000
    s_mov_b32 s11, 0x00020000
    s_add_u32 s12, s4, 0xddfa000
    s_addc_u32 s13, s5, 0
    s_mov_b32 s14, 0x51000
    s_mov_b32 s15, 0x00020000
    v_lshrrev_b32 v14, 5, v1
    v_lshlrev_b32 v14, 10, v14
    v_bfe_u32 v15, v1, 4, 1
    v_lshl_add_u32 v14, v15, 9, v14
    v_bfe_u32 v15, v1, 2, 2
    v_lshl_add_u32 v14, v15, 7, v14
    v_and_b32 v15, 3, v1
    v_lshl_add_u32 v14, v15, 3, v14
    v_and_b32 v15, 15, v1
    v_lshlrev_b32 v15, 2, v15
    v_mov_b32 v16, 0x3f803f80
    s_cmp_ge_u32 s28, 6
    s_cbranch_scc1 k1_kernel_timm
    s_lshl_b32 s35, s28, 12
    s_add_u32 s35, s35, 113664
    v_add_u32 v18, s35, v14
    ds_read_b64_tr_b16 v[200:201], v18 offset:0
    ds_read_b64_tr_b16 v[202:203], v18 offset:2048
    ds_read_b64_tr_b16 v[204:205], v18 offset:32
    ds_read_b64_tr_b16 v[206:207], v18 offset:2080
    ds_read_b64_tr_b16 v[208:209], v18 offset:64
    ds_read_b64_tr_b16 v[210:211], v18 offset:2112
    ds_read_b64_tr_b16 v[212:213], v18 offset:96
    ds_read_b64_tr_b16 v[214:215], v18 offset:2144
    s_lshl_b32 s35, s28, 2
    s_mul_i32 s36, s35, s64
    s_add_u32 s36, s36, s59
    s_lshl_b32 s36, s36, 10
    s_lshl_b32 s37, s64, 10
    s_lshl_b32 s35, s35, 6
    s_add_u32 s35, s35, s53
    s_waitcnt lgkmcnt(0)
    s_cmp_eq_u32 s65, 1
    s_cbranch_scc0 k1_kernel_nocs_1
    v_mov_b32 v220, 0
    v_mov_b32 v221, 0
    v_mov_b32 v222, 0
    v_mov_b32 v223, 0
    v_dot2_f32_bf16 v220, v200, v16, v220
    v_dot2_f32_bf16 v221, v204, v16, v221
    v_dot2_f32_bf16 v222, v208, v16, v222
    v_dot2_f32_bf16 v223, v212, v16, v223
    v_dot2_f32_bf16 v220, v201, v16, v220
    v_dot2_f32_bf16 v221, v205, v16, v221
    v_dot2_f32_bf16 v222, v209, v16, v222
    v_dot2_f32_bf16 v223, v213, v16, v223
    v_dot2_f32_bf16 v220, v202, v16, v220
    v_dot2_f32_bf16 v221, v206, v16, v221
    v_dot2_f32_bf16 v222, v210, v16, v222
    v_dot2_f32_bf16 v223, v214, v16, v223
    v_dot2_f32_bf16 v220, v203, v16, v220
    v_dot2_f32_bf16 v221, v207, v16, v221
    v_dot2_f32_bf16 v222, v211, v16, v222
    v_dot2_f32_bf16 v223, v215, v16, v223
    s_nop 1
    v_mov_b32 v17, v220
    s_nop 1
    v_permlane16_swap_b32 v220, v17
    v_add_f32 v220, v220, v17
    v_mov_b32 v17, v220
    s_nop 1
    v_permlane32_swap_b32 v220, v17
    v_add_f32 v220, v220, v17
    v_mov_b32 v17, v221
    s_nop 1
    v_permlane16_swap_b32 v221, v17
    v_add_f32 v221, v221, v17
    v_mov_b32 v17, v221
    s_nop 1
    v_permlane32_swap_b32 v221, v17
    v_add_f32 v221, v221, v17
    v_mov_b32 v17, v222
    s_nop 1
    v_permlane16_swap_b32 v222, v17
    v_add_f32 v222, v222, v17
    v_mov_b32 v17, v222
    s_nop 1
    v_permlane32_swap_b32 v222, v17
    v_add_f32 v222, v222, v17
    v_mov_b32 v17, v223
    s_nop 1
    v_permlane16_swap_b32 v223, v17
    v_add_f32 v223, v223, v17
    v_mov_b32 v17, v223
    s_nop 1
    v_permlane32_swap_b32 v223, v17
    v_add_f32 v223, v223, v17
k1_kernel_nocs_1:
    s_branch k1_kernel_tdone
k1_kernel_timm:
    s_lshl_b32 s35, s28, 12
    s_add_u32 s35, s35, 113664
    v_add_u32 v18, s35, v14
    ds_read_b64_tr_b16 v[200:201], v18 offset:0
    ds_read_b64_tr_b16 v[202:203], v18 offset:2048
    ds_read_b64_tr_b16 v[204:205], v18 offset:32
    ds_read_b64_tr_b16 v[206:207], v18 offset:2080
    ds_read_b64_tr_b16 v[208:209], v18 offset:64
    ds_read_b64_tr_b16 v[210:211], v18 offset:2112
    ds_read_b64_tr_b16 v[212:213], v18 offset:96
    ds_read_b64_tr_b16 v[214:215], v18 offset:2144
    s_lshl_b32 s35, s28, 2
    s_mul_i32 s36, s35, s64
    s_add_u32 s36, s36, s59
    s_lshl_b32 s36, s36, 10
    s_lshl_b32 s37, s64, 10
    s_lshl_b32 s35, s35, 6
    s_add_u32 s35, s35, s53
    s_waitcnt lgkmcnt(0)
    s_cmp_eq_u32 s65, 1
    s_cbranch_scc0 k1_kernel_nocs_2
    v_mov_b32 v220, 0
    v_mov_b32 v221, 0
    v_mov_b32 v222, 0
    v_mov_b32 v223, 0
    v_dot2_f32_bf16 v220, v200, v16, v220
    v_dot2_f32_bf16 v221, v204, v16, v221
    v_dot2_f32_bf16 v222, v208, v16, v222
    v_dot2_f32_bf16 v223, v212, v16, v223
    v_dot2_f32_bf16 v220, v201, v16, v220
    v_dot2_f32_bf16 v221, v205, v16, v221
    v_dot2_f32_bf16 v222, v209, v16, v222
    v_dot2_f32_bf16 v223, v213, v16, v223
    v_dot2_f32_bf16 v220, v202, v16, v220
    v_dot2_f32_bf16 v221, v206, v16, v221
    v_dot2_f32_bf16 v222, v210, v16, v222
    v_dot2_f32_bf16 v223, v214, v16, v223
    v_dot2_f32_bf16 v220, v203, v16, v220
    v_dot2_f32_bf16 v221, v207, v16, v221
    v_dot2_f32_bf16 v222, v211, v16, v222
    v_dot2_f32_bf16 v223, v215, v16, v223
    s_nop 1
    v_mov_b32 v17, v220
    s_nop 1
    v_permlane16_swap_b32 v220, v17
    v_add_f32 v220, v220, v17
    v_mov_b32 v17, v220
    s_nop 1
    v_permlane32_swap_b32 v220, v17
    v_add_f32 v220, v220, v17
    v_mov_b32 v17, v221
    s_nop 1
    v_permlane16_swap_b32 v221, v17
    v_add_f32 v221, v221, v17
    v_mov_b32 v17, v221
    s_nop 1
    v_permlane32_swap_b32 v221, v17
    v_add_f32 v221, v221, v17
    v_mov_b32 v17, v222
    s_nop 1
    v_permlane16_swap_b32 v222, v17
    v_add_f32 v222, v222, v17
    v_mov_b32 v17, v222
    s_nop 1
    v_permlane32_swap_b32 v222, v17
    v_add_f32 v222, v222, v17
    v_mov_b32 v17, v223
    s_nop 1
    v_permlane16_swap_b32 v223, v17
    v_add_f32 v223, v223, v17
    v_mov_b32 v17, v223
    s_nop 1
    v_permlane32_swap_b32 v223, v17
    v_add_f32 v223, v223, v17
k1_kernel_nocs_2:
    buffer_store_dwordx4 v[200:203], v2, s[8:11], s36 offen sc1
    s_add_u32 s36, s36, s37
    buffer_store_dwordx4 v[204:207], v2, s[8:11], s36 offen sc1
    s_add_u32 s36, s36, s37
    buffer_store_dwordx4 v[208:211], v2, s[8:11], s36 offen sc1
    s_add_u32 s36, s36, s37
    buffer_store_dwordx4 v[212:215], v2, s[8:11], s36 offen sc1
    s_add_u32 s36, s36, s37
    s_cmp_eq_u32 s65, 1
    s_cbranch_scc0 k1_kernel_nocs2_3
    v_and_b32 v19, 15, v1
    v_lshlrev_b32 v19, 2, v19
    s_mov_b64 exec, 0xffff
    buffer_store_dword v220, v19, s[12:15], s35 offen offset:0
    buffer_store_dword v221, v19, s[12:15], s35 offen offset:64
    buffer_store_dword v222, v19, s[12:15], s35 offen offset:128
    buffer_store_dword v223, v19, s[12:15], s35 offen offset:192
    s_mov_b64 exec, -1
k1_kernel_nocs2_3:
    s_cmp_lg_u32 s28, 7
    s_cbranch_scc1 k1_kernel_tdone
    s_mov_b32 s34, 8
    s_nop 1
    s_lshl_b32 s35, s34, 12
    s_add_u32 s35, s35, 113664
    v_add_u32 v18, s35, v14
    ds_read_b64_tr_b16 v[200:201], v18 offset:0
    ds_read_b64_tr_b16 v[202:203], v18 offset:2048
    ds_read_b64_tr_b16 v[204:205], v18 offset:32
    ds_read_b64_tr_b16 v[206:207], v18 offset:2080
    ds_read_b64_tr_b16 v[208:209], v18 offset:64
    ds_read_b64_tr_b16 v[210:211], v18 offset:2112
    ds_read_b64_tr_b16 v[212:213], v18 offset:96
    ds_read_b64_tr_b16 v[214:215], v18 offset:2144
    s_lshl_b32 s35, s34, 2
    s_mul_i32 s36, s35, s64
    s_add_u32 s36, s36, s59
    s_lshl_b32 s36, s36, 10
    s_lshl_b32 s37, s64, 10
    s_lshl_b32 s35, s35, 6
    s_add_u32 s35, s35, s53
    s_waitcnt lgkmcnt(0)
    s_cmp_eq_u32 s65, 1
    s_cbranch_scc0 k1_kernel_nocs_4
    v_mov_b32 v220, 0
    v_mov_b32 v221, 0
    v_mov_b32 v222, 0
    v_mov_b32 v223, 0
    v_dot2_f32_bf16 v220, v200, v16, v220
    v_dot2_f32_bf16 v221, v204, v16, v221
    v_dot2_f32_bf16 v222, v208, v16, v222
    v_dot2_f32_bf16 v223, v212, v16, v223
    v_dot2_f32_bf16 v220, v201, v16, v220
    v_dot2_f32_bf16 v221, v205, v16, v221
    v_dot2_f32_bf16 v222, v209, v16, v222
    v_dot2_f32_bf16 v223, v213, v16, v223
    v_dot2_f32_bf16 v220, v202, v16, v220
    v_dot2_f32_bf16 v221, v206, v16, v221
    v_dot2_f32_bf16 v222, v210, v16, v222
    v_dot2_f32_bf16 v223, v214, v16, v223
    v_dot2_f32_bf16 v220, v203, v16, v220
    v_dot2_f32_bf16 v221, v207, v16, v221
    v_dot2_f32_bf16 v222, v211, v16, v222
    v_dot2_f32_bf16 v223, v215, v16, v223
    s_nop 1
    v_mov_b32 v17, v220
    s_nop 1
    v_permlane16_swap_b32 v220, v17
    v_add_f32 v220, v220, v17
    v_mov_b32 v17, v220
    s_nop 1
    v_permlane32_swap_b32 v220, v17
    v_add_f32 v220, v220, v17
    v_mov_b32 v17, v221
    s_nop 1
    v_permlane16_swap_b32 v221, v17
    v_add_f32 v221, v221, v17
    v_mov_b32 v17, v221
    s_nop 1
    v_permlane32_swap_b32 v221, v17
    v_add_f32 v221, v221, v17
    v_mov_b32 v17, v222
    s_nop 1
    v_permlane16_swap_b32 v222, v17
    v_add_f32 v222, v222, v17
    v_mov_b32 v17, v222
    s_nop 1
    v_permlane32_swap_b32 v222, v17
    v_add_f32 v222, v222, v17
    v_mov_b32 v17, v223
    s_nop 1
    v_permlane16_swap_b32 v223, v17
    v_add_f32 v223, v223, v17
    v_mov_b32 v17, v223
    s_nop 1
    v_permlane32_swap_b32 v223, v17
    v_add_f32 v223, v223, v17
k1_kernel_nocs_4:
    buffer_store_dwordx4 v[200:203], v2, s[8:11], s36 offen sc1
    s_add_u32 s36, s36, s37
    buffer_store_dwordx4 v[204:207], v2, s[8:11], s36 offen sc1
    s_add_u32 s36, s36, s37
    buffer_store_dwordx4 v[208:211], v2, s[8:11], s36 offen sc1
    s_add_u32 s36, s36, s37
    buffer_store_dwordx4 v[212:215], v2, s[8:11], s36 offen sc1
    s_add_u32 s36, s36, s37
    s_cmp_eq_u32 s65, 1
    s_cbranch_scc0 k1_kernel_nocs2_5
    v_and_b32 v19, 15, v1
    v_lshlrev_b32 v19, 2, v19
    s_mov_b64 exec, 0xffff
    buffer_store_dword v220, v19, s[12:15], s35 offen offset:0
    buffer_store_dword v221, v19, s[12:15], s35 offen offset:64
    buffer_store_dword v222, v19, s[12:15], s35 offen offset:128
    buffer_store_dword v223, v19, s[12:15], s35 offen offset:192
    s_mov_b64 exec, -1
k1_kernel_nocs2_5:
k1_kernel_tdone:
    s_cmp_ge_u32 s28, 6
    s_cbranch_scc1 k1_kernel_skipkv
    v_mov_b32 v44, 0
    v_mov_b32 v45, 0
    v_mov_b32 v46, 0
    v_mov_b32 v47, 0
    s_mov_b64 exec, s[42:43]
    s_mov_b32 s48, 20000
k1_kernel_poll:
    s_mov_b32 s49, s46
    buffer_load_dwordx4 v[112:115], v2, s[20:23], s49 offen sc1
    s_add_u32 s49, s49, 6144
    buffer_load_dwordx4 v[116:119], v2, s[20:23], s49 offen sc1
    s_add_u32 s49, s49, 6144
    buffer_load_dwordx4 v[120:123], v2, s[20:23], s49 offen sc1
    s_add_u32 s49, s49, 6144
    buffer_load_dwordx4 v[124:127], v2, s[20:23], s49 offen sc1
    s_add_u32 s49, s49, 6144
    buffer_load_dwordx4 v[128:131], v2, s[20:23], s49 offen sc1
    s_add_u32 s49, s49, 6144
    buffer_load_dwordx4 v[132:135], v2, s[20:23], s49 offen sc1
    s_add_u32 s49, s49, 6144
    buffer_load_dwordx4 v[136:139], v2, s[20:23], s49 offen sc1
    s_add_u32 s49, s49, 6144
    buffer_load_dwordx4 v[140:143], v2, s[20:23], s49 offen sc1
    s_waitcnt vmcnt(0)
    v_max3_u32 v14, v112, v113, v114
    v_max3_u32 v14, v14, v115, v116
    v_max3_u32 v14, v14, v117, v118
    v_max3_u32 v14, v14, v119, v120
    v_max3_u32 v14, v14, v121, v122
    v_max3_u32 v14, v14, v123, v124
    v_max3_u32 v14, v14, v125, v126
    v_max3_u32 v14, v14, v127, v128
    v_max3_u32 v14, v14, v129, v130
    v_max3_u32 v14, v14, v131, v132
    v_max3_u32 v14, v14, v133, v134
    v_max3_u32 v14, v14, v135, v136
    v_max3_u32 v14, v14, v137, v138
    v_max3_u32 v14, v14, v139, v140
    v_max3_u32 v14, v14, v141, v142
    v_max_u32 v14, v14, v143
    v_cmp_eq_u32 vcc, -1, v14
    s_cbranch_vccz k1_kernel_got
    s_sub_u32 s48, s48, 1
    s_cmp_eq_u32 s48, 0
    s_cbranch_scc1 k1_kernel_got
    s_sleep 2
    s_branch k1_kernel_poll
k1_kernel_got:
    v_add_f32 v44, v112, v116
    v_add_f32 v45, v113, v117
    v_add_f32 v46, v114, v118
    v_add_f32 v47, v115, v119
    v_add_f32 v44, v44, v120
    v_add_f32 v45, v45, v121
    v_add_f32 v46, v46, v122
    v_add_f32 v47, v47, v123
    v_add_f32 v44, v44, v124
    v_add_f32 v45, v45, v125
    v_add_f32 v46, v46, v126
    v_add_f32 v47, v47, v127
    v_add_f32 v44, v44, v128
    v_add_f32 v45, v45, v129
    v_add_f32 v46, v46, v130
    v_add_f32 v47, v47, v131
    v_add_f32 v44, v44, v132
    v_add_f32 v45, v45, v133
    v_add_f32 v46, v46, v134
    v_add_f32 v47, v47, v135
    v_add_f32 v44, v44, v136
    v_add_f32 v45, v45, v137
    v_add_f32 v46, v46, v138
    v_add_f32 v47, v47, v139
    v_add_f32 v44, v44, v140
    v_add_f32 v45, v45, v141
    v_add_f32 v46, v46, v142
    v_add_f32 v47, v47, v143
    s_mov_b64 exec, s[50:51]
    v_cvt_pk_bf16_f32 v48, v44, v45
    v_cvt_pk_bf16_f32 v49, v46, v47
    s_lshl_b32 s42, s41, 4
    v_add_u32 v14, s42, v13
    v_cmp_le_u32 vcc, 10, v14
    v_subrev_u32 v15, 10, v14
    s_nop 0
    v_cndmask_b32 v15, v14, v15, vcc
    v_cndmask_b32 v16, 0, 4, vcc
    v_lshrrev_b32 v17, 2, v15
    v_lshl_add_u32 v16, v17, 3, v16
    v_and_b32 v17, 3, v15
    v_add_u32 v16, v16, v17
    v_mul_u32_u24 v16, 96, v16
    v_lshl_add_u32 v16, v9, 3, v16
    s_lshl_b32 s42, s40, 5
    s_add_u32 s42, s42, 110592
    v_add_u32 v16, s42, v16
    s_mov_b64 exec, s[44:45]
    ds_write_b64 v16, v[48:49]
    s_cmp_eq_u32 s41, 0
    s_cbranch_scc1 k1_kernel_nodup
    s_mov_b32 s42, 0x00100010
    s_mov_b32 s43, 0x00100010
    s_mov_b64 exec, s[42:43]
    v_subrev_u32 v16, 384, v16
    ds_write_b64 v16, v[48:49]
k1_kernel_nodup:
    s_mov_b64 exec, s[50:51]
    buffer_store_dwordx4 v[200:203], v2, s[8:11], s36 offen sc1
    s_add_u32 s36, s36, s37
    buffer_store_dwordx4 v[204:207], v2, s[8:11], s36 offen sc1
    s_add_u32 s36, s36, s37
    buffer_store_dwordx4 v[208:211], v2, s[8:11], s36 offen sc1
    s_add_u32 s36, s36, s37
    buffer_store_dwordx4 v[212:215], v2, s[8:11], s36 offen sc1
    s_add_u32 s36, s36, s37
    s_cmp_eq_u32 s65, 1
    s_cbranch_scc0 k1_kernel_nocs2_6
    v_and_b32 v19, 15, v1
    v_lshlrev_b32 v19, 2, v19
    s_mov_b64 exec, 0xffff
    buffer_store_dword v220, v19, s[12:15], s35 offen offset:0
    buffer_store_dword v221, v19, s[12:15], s35 offen offset:64
    buffer_store_dword v222, v19, s[12:15], s35 offen offset:128
    buffer_store_dword v223, v19, s[12:15], s35 offen offset:192
    s_mov_b64 exec, -1
k1_kernel_nocs2_6:
k1_kernel_skipkv:
    s_waitcnt lgkmcnt(0)
    s_barrier
    v_and_b32 v9, 31, v1
    v_mul_u32_u24 v9, 96, v9
    v_lshl_add_u32 v9, v4, 4, v9
    v_add_u32 v9, 110592, v9
    ds_read_b128 v[24:27], v9 offset:0
    ds_read_b128 v[28:31], v9 offset:32
    ds_read_b128 v[32:35], v9 offset:64
    s_lshl_b32 s42, s30, 8
    s_add_u32 s42, s42, s38
    v_and_b32 v10, 31, v1
    v_add_u32 v10, s42, v10
    v_lshrrev_b32 v11, 4, v10
    v_mul_u32_u24 v11, 18432, v11
    v_and_b32 v12, 15, v10
    v_lshl_add_u32 v11, v12, 4, v11
    s_mul_i32 s42, s29, 18
    v_mul_u32_u24 v12, 10, v4
    v_add_u32 v12, s42, v12
    s_waitcnt lgkmcnt(2)
    v_mfma_f32_32x32x16_bf16 v[56:71], v[24:27], v[180:183], 0
    s_waitcnt lgkmcnt(1)
    v_mfma_f32_32x32x16_bf16 v[56:71], v[28:31], v[188:191], v[56:71]
    s_waitcnt lgkmcnt(0)
    v_mfma_f32_32x32x16_bf16 v[56:71], v[32:35], v[196:199], v[56:71]
    v_add_u32 v13, 0, v12
    v_lshrrev_b32 v14, 5, v13
    v_lshl_add_u32 v16, v14, 10, v11
    v_bfe_u32 v14, v13, 2, 2
    v_lshl_add_u32 v16, v14, 8, v16
    v_bfe_u32 v14, v13, 4, 1
    v_lshl_add_u32 v16, v14, 3, v16
    v_and_b32 v14, 3, v13
    v_lshl_add_u32 v16, v14, 1, v16
    v_add_u32 v13, 2, v12
    v_lshrrev_b32 v14, 5, v13
    v_lshl_add_u32 v17, v14, 10, v11
    v_bfe_u32 v14, v13, 2, 2
    v_lshl_add_u32 v17, v14, 8, v17
    v_bfe_u32 v14, v13, 4, 1
    v_lshl_add_u32 v17, v14, 3, v17
    v_and_b32 v14, 3, v13
    v_lshl_add_u32 v17, v14, 1, v17
    v_add_u32 v13, 4, v12
    v_lshrrev_b32 v14, 5, v13
    v_lshl_add_u32 v18, v14, 10, v11
    v_bfe_u32 v14, v13, 2, 2
    v_lshl_add_u32 v18, v14, 8, v18
    v_bfe_u32 v14, v13, 4, 1
    v_lshl_add_u32 v18, v14, 3, v18
    v_and_b32 v14, 3, v13
    v_lshl_add_u32 v18, v14, 1, v18
    v_add_u32 v13, 6, v12
    v_lshrrev_b32 v14, 5, v13
    v_lshl_add_u32 v19, v14, 10, v11
    v_bfe_u32 v14, v13, 2, 2
    v_lshl_add_u32 v19, v14, 8, v19
    v_bfe_u32 v14, v13, 4, 1
    v_lshl_add_u32 v19, v14, 3, v19
    v_and_b32 v14, 3, v13
    v_lshl_add_u32 v19, v14, 1, v19
    v_add_u32 v13, 8, v12
    v_lshrrev_b32 v14, 5, v13
    v_lshl_add_u32 v20, v14, 10, v11
    v_bfe_u32 v14, v13, 2, 2
    v_lshl_add_u32 v20, v14, 8, v20
    v_bfe_u32 v14, v13, 4, 1
    v_lshl_add_u32 v20, v14, 3, v20
    v_and_b32 v14, 3, v13
    v_lshl_add_u32 v20, v14, 1, v20
    v_add_f32 v22, 0x358637bd, v66
    v_rcp_f32 v22, v22
    s_nop 0
    v_mul_f32 v56, v22, v56
    v_mul_f32 v57, v22, v57
    v_mul_f32 v58, v22, v58
    v_mul_f32 v59, v22, v59
    v_mul_f32 v60, v22, v60
    v_mul_f32 v61, v22, v61
    v_mul_f32 v62, v22, v62
    v_mul_f32 v63, v22, v63
    v_mul_f32 v64, v22, v64
    v_mul_f32 v65, v22, v65
    v_cvt_pk_bf16_f32 v40, v56, v57
    v_cvt_pk_bf16_f32 v41, v58, v59
    v_cvt_pk_bf16_f32 v42, v60, v61
    v_cvt_pk_bf16_f32 v43, v62, v63
    v_cvt_pk_bf16_f32 v44, v64, v65
    buffer_store_dword v40, v16, s[24:27], 0 offen
    buffer_store_dword v41, v17, s[24:27], 0 offen
    buffer_store_dword v42, v18, s[24:27], 0 offen
    buffer_store_dword v43, v19, s[24:27], 0 offen
    s_mov_b32 exec_hi, 0
    buffer_store_dword v44, v20, s[24:27], 0 offen
k1_kernel_done:
    s_endpgm

.globl k2_kernel
.p2align 8
.type k2_kernel,@function
k2_kernel:
    s_cmp_ge_u32 s2, 256
    s_cbranch_scc1 k2_kernel_done
    s_load_dwordx2 s[4:5], s[0:1], 88
    s_load_dwordx2 s[6:7], s[0:1], 0
    s_load_dwordx2 s[54:55], s[0:1], 48
    v_lshrrev_b32 v2, 6, v0
    v_and_b32 v1, 63, v0
    v_readfirstlane_b32 s28, v2
    s_and_b32 s31, s2, 7
    s_lshr_b32 s32, s2, 3
    s_and_b32 s29, s32, 7
    s_lshr_b32 s30, s32, 3
    s_lshl_b32 s33, s31, 2
    s_add_u32 s30, s30, s33
    v_lshlrev_b32 v2, 4, v1
    s_lshr_b32 s35, s29, 1
    s_mul_i32 s35, s35, 9
    s_and_b32 s36, s29, 1
    s_mul_i32 s37, s36, 5
    s_add_u32 s35, s35, s37
    s_lshl_b32 s49, s36, 30
    s_waitcnt lgkmcnt(0)
    s_add_u32 s12, s4, 0xccb0000
    s_addc_u32 s13, s5, 0
    s_mov_b32 s14, 0xa2000
    s_mov_b32 s15, 0x00020000
    s_add_u32 s8, s4, 0xd93a000
    s_addc_u32 s9, s5, 0
    s_mov_b32 s10, 0x240000
    s_mov_b32 s11, 0x00020000
    s_mul_i32 s44, s35, 18432
    s_lshl_b32 s36, s30, 2
    s_add_u32 s36, s36, s28
    s_mul_i32 s36, s36, 18432
    v_add_u32 v6, 0x8000, v2
    v_add_u32 v7, 0x10000, v2
    s_cmp_lg_u32 s28, 0
    s_cbranch_scc1 k2_kernel_ip0_1
    s_add_u32 s43, s44, 0
    s_mov_b32 m0, 0
    s_nop 0
    buffer_load_dwordx4 v2, s[12:15], s43 offen lds
    s_add_u32 s43, s44, 73728
    s_add_u32 s43, s43, s49
    s_mov_b32 m0, 4096
    s_nop 0
    buffer_load_dwordx4 v2, s[12:15], s43 offen lds
    s_add_u32 s43, s44, 56320
    s_mov_b32 m0, 8192
    s_nop 0
    buffer_load_dwordx4 v2, s[12:15], s43 offen lds
    s_add_u32 s43, s44, 38912
    s_mov_b32 m0, 12288
    s_nop 0
    buffer_load_dwordx4 v2, s[12:15], s43 offen lds
    s_add_u32 s43, s44, 21504
    s_mov_b32 m0, 16384
    s_nop 0
    buffer_load_dwordx4 v2, s[12:15], s43 offen lds
    s_add_u32 s43, s44, 4096
    s_mov_b32 m0, 20480
    s_nop 0
    buffer_load_dwordx4 v2, s[12:15], s43 offen lds
    s_add_u32 s43, s44, 77824
    s_add_u32 s43, s43, s49
    s_mov_b32 m0, 24576
    s_nop 0
    buffer_load_dwordx4 v2, s[12:15], s43 offen lds
    s_add_u32 s43, s44, 60416
    s_mov_b32 m0, 28672
    s_nop 0
    buffer_load_dwordx4 v2, s[12:15], s43 offen lds
    s_branch k2_kernel_ipd0
k2_kernel_ip0_1:
    s_cmp_lg_u32 s28, 1
    s_cbranch_scc1 k2_kernel_ip0_2
    s_add_u32 s43, s44, 18432
    s_mov_b32 m0, 1024
    s_nop 0
    buffer_load_dwordx4 v2, s[12:15], s43 offen lds
    s_add_u32 s43, s44, 1024
    s_mov_b32 m0, 5120
    s_nop 0
    buffer_load_dwordx4 v2, s[12:15], s43 offen lds
    s_add_u32 s43, s44, 74752
    s_add_u32 s43, s43, s49
    s_mov_b32 m0, 9216
    s_nop 0
    buffer_load_dwordx4 v2, s[12:15], s43 offen lds
    s_add_u32 s43, s44, 57344
    s_mov_b32 m0, 13312
    s_nop 0
    buffer_load_dwordx4 v2, s[12:15], s43 offen lds
    s_add_u32 s43, s44, 39936
    s_mov_b32 m0, 17408
    s_nop 0
    buffer_load_dwordx4 v2, s[12:15], s43 offen lds
    s_add_u32 s43, s44, 22528
    s_mov_b32 m0, 21504
    s_nop 0
    buffer_load_dwordx4 v2, s[12:15], s43 offen lds
    s_add_u32 s43, s44, 5120
    s_mov_b32 m0, 25600
    s_nop 0
    buffer_load_dwordx4 v2, s[12:15], s43 offen lds
    s_add_u32 s43, s44, 78848
    s_add_u32 s43, s43, s49
    s_mov_b32 m0, 29696
    s_nop 0
    buffer_load_dwordx4 v2, s[12:15], s43 offen lds
    s_branch k2_kernel_ipd0
k2_kernel_ip0_2:
    s_cmp_lg_u32 s28, 2
    s_cbranch_scc1 k2_kernel_ip0_3
    s_add_u32 s43, s44, 36864
    s_mov_b32 m0, 2048
    s_nop 0
    buffer_load_dwordx4 v2, s[12:15], s43 offen lds
    s_add_u32 s43, s44, 19456
    s_mov_b32 m0, 6144
    s_nop 0
    buffer_load_dwordx4 v2, s[12:15], s43 offen lds
    s_add_u32 s43, s44, 2048
    s_mov_b32 m0, 10240
    s_nop 0
    buffer_load_dwordx4 v2, s[12:15], s43 offen lds
    s_add_u32 s43, s44, 75776
    s_add_u32 s43, s43, s49
    s_mov_b32 m0, 14336
    s_nop 0
    buffer_load_dwordx4 v2, s[12:15], s43 offen lds
    s_add_u32 s43, s44, 58368
    s_mov_b32 m0, 18432
    s_nop 0
    buffer_load_dwordx4 v2, s[12:15], s43 offen lds
    s_add_u32 s43, s44, 40960
    s_mov_b32 m0, 22528
    s_nop 0
    buffer_load_dwordx4 v2, s[12:15], s43 offen lds
    s_add_u32 s43, s44, 23552
    s_mov_b32 m0, 26624
    s_nop 0
    buffer_load_dwordx4 v2, s[12:15], s43 offen lds
    s_branch k2_kernel_ipd0
k2_kernel_ip0_3:
    s_add_u32 s43, s44, 55296
    s_mov_b32 m0, 3072
    s_nop 0
    buffer_load_dwordx4 v2, s[12:15], s43 offen lds
    s_add_u32 s43, s44, 37888
    s_mov_b32 m0, 7168
    s_nop 0
    buffer_load_dwordx4 v2, s[12:15], s43 offen lds
    s_add_u32 s43, s44, 20480
    s_mov_b32 m0, 11264
    s_nop 0
    buffer_load_dwordx4 v2, s[12:15], s43 offen lds
    s_add_u32 s43, s44, 3072
    s_mov_b32 m0, 15360
    s_nop 0
    buffer_load_dwordx4 v2, s[12:15], s43 offen lds
    s_add_u32 s43, s44, 76800
    s_add_u32 s43, s43, s49
    s_mov_b32 m0, 19456
    s_nop 0
    buffer_load_dwordx4 v2, s[12:15], s43 offen lds
    s_add_u32 s43, s44, 59392
    s_mov_b32 m0, 23552
    s_nop 0
    buffer_load_dwordx4 v2, s[12:15], s43 offen lds
    s_add_u32 s43, s44, 41984
    s_mov_b32 m0, 27648
    s_nop 0
    buffer_load_dwordx4 v2, s[12:15], s43 offen lds
k2_kernel_ipd0:
    buffer_load_dwordx4 v[112:115], v2, s[8:11], s36 offen offset:0
    buffer_load_dwordx4 v[116:119], v2, s[8:11], s36 offen offset:1024
    buffer_load_dwordx4 v[120:123], v2, s[8:11], s36 offen offset:2048
    buffer_load_dwordx4 v[124:127], v2, s[8:11], s36 offen offset:3072
    s_add_u32 s36, s36, 4096
    buffer_load_dwordx4 v[128:131], v2, s[8:11], s36 offen offset:0
    buffer_load_dwordx4 v[132:135], v2, s[8:11], s36 offen offset:1024
    s_cmp_lg_u32 s28, 0
    s_cbranch_scc1 k2_kernel_ip1_1
    s_add_u32 s43, s44, 6144
    s_mov_b32 m0, 32768
    s_nop 0
    buffer_load_dwordx4 v2, s[12:15], s43 offen lds
    s_add_u32 s43, s44, 79872
    s_add_u32 s43, s43, s49
    s_mov_b32 m0, 36864
    s_nop 0
    buffer_load_dwordx4 v2, s[12:15], s43 offen lds
    s_add_u32 s43, s44, 62464
    s_mov_b32 m0, 40960
    s_nop 0
    buffer_load_dwordx4 v2, s[12:15], s43 offen lds
    s_add_u32 s43, s44, 45056
    s_mov_b32 m0, 45056
    s_nop 0
    buffer_load_dwordx4 v2, s[12:15], s43 offen lds
    s_add_u32 s43, s44, 27648
    s_mov_b32 m0, 49152
    s_nop 0
    buffer_load_dwordx4 v2, s[12:15], s43 offen lds
    s_add_u32 s43, s44, 10240
    s_mov_b32 m0, 53248
    s_nop 0
    buffer_load_dwordx4 v2, s[12:15], s43 offen lds
    s_add_u32 s43, s44, 83968
    s_add_u32 s43, s43, s49
    s_mov_b32 m0, 57344
    s_nop 0
    buffer_load_dwordx4 v2, s[12:15], s43 offen lds
    s_add_u32 s43, s44, 66560
    s_mov_b32 m0, 61440
    s_nop 0
    buffer_load_dwordx4 v2, s[12:15], s43 offen lds
    s_branch k2_kernel_ipd1
k2_kernel_ip1_1:
    s_cmp_lg_u32 s28, 1
    s_cbranch_scc1 k2_kernel_ip1_2
    s_add_u32 s43, s44, 24576
    s_mov_b32 m0, 33792
    s_nop 0
    buffer_load_dwordx4 v2, s[12:15], s43 offen lds
    s_add_u32 s43, s44, 7168
    s_mov_b32 m0, 37888
    s_nop 0
    buffer_load_dwordx4 v2, s[12:15], s43 offen lds
    s_add_u32 s43, s44, 80896
    s_add_u32 s43, s43, s49
    s_mov_b32 m0, 41984
    s_nop 0
    buffer_load_dwordx4 v2, s[12:15], s43 offen lds
    s_add_u32 s43, s44, 63488
    s_mov_b32 m0, 46080
    s_nop 0
    buffer_load_dwordx4 v2, s[12:15], s43 offen lds
    s_add_u32 s43, s44, 46080
    s_mov_b32 m0, 50176
    s_nop 0
    buffer_load_dwordx4 v2, s[12:15], s43 offen lds
    s_add_u32 s43, s44, 28672
    s_mov_b32 m0, 54272
    s_nop 0
    buffer_load_dwordx4 v2, s[12:15], s43 offen lds
    s_add_u32 s43, s44, 11264
    s_mov_b32 m0, 58368
    s_nop 0
    buffer_load_dwordx4 v2, s[12:15], s43 offen lds
    s_add_u32 s43, s44, 84992
    s_add_u32 s43, s43, s49
    s_mov_b32 m0, 62464
    s_nop 0
    buffer_load_dwordx4 v2, s[12:15], s43 offen lds
    s_branch k2_kernel_ipd1
k2_kernel_ip1_2:
    s_cmp_lg_u32 s28, 2
    s_cbranch_scc1 k2_kernel_ip1_3
    s_add_u32 s43, s44, 43008
    s_mov_b32 m0, 34816
    s_nop 0
    buffer_load_dwordx4 v2, s[12:15], s43 offen lds
    s_add_u32 s43, s44, 25600
    s_mov_b32 m0, 38912
    s_nop 0
    buffer_load_dwordx4 v2, s[12:15], s43 offen lds
    s_add_u32 s43, s44, 8192
    s_mov_b32 m0, 43008
    s_nop 0
    buffer_load_dwordx4 v2, s[12:15], s43 offen lds
    s_add_u32 s43, s44, 81920
    s_add_u32 s43, s43, s49
    s_mov_b32 m0, 47104
    s_nop 0
    buffer_load_dwordx4 v2, s[12:15], s43 offen lds
    s_add_u32 s43, s44, 64512
    s_mov_b32 m0, 51200
    s_nop 0
    buffer_load_dwordx4 v2, s[12:15], s43 offen lds
    s_add_u32 s43, s44, 47104
    s_mov_b32 m0, 55296
    s_nop 0
    buffer_load_dwordx4 v2, s[12:15], s43 offen lds
    s_add_u32 s43, s44, 29696
    s_mov_b32 m0, 59392
    s_nop 0
    buffer_load_dwordx4 v2, s[12:15], s43 offen lds
    s_branch k2_kernel_ipd1
k2_kernel_ip1_3:
    s_add_u32 s43, s44, 61440
    s_mov_b32 m0, 35840
    s_nop 0
    buffer_load_dwordx4 v2, s[12:15], s43 offen lds
    s_add_u32 s43, s44, 44032
    s_mov_b32 m0, 39936
    s_nop 0
    buffer_load_dwordx4 v2, s[12:15], s43 offen lds
    s_add_u32 s43, s44, 26624
    s_mov_b32 m0, 44032
    s_nop 0
    buffer_load_dwordx4 v2, s[12:15], s43 offen lds
    s_add_u32 s43, s44, 9216
    s_mov_b32 m0, 48128
    s_nop 0
    buffer_load_dwordx4 v2, s[12:15], s43 offen lds
    s_add_u32 s43, s44, 82944
    s_add_u32 s43, s43, s49
    s_mov_b32 m0, 52224
    s_nop 0
    buffer_load_dwordx4 v2, s[12:15], s43 offen lds
    s_add_u32 s43, s44, 65536
    s_mov_b32 m0, 56320
    s_nop 0
    buffer_load_dwordx4 v2, s[12:15], s43 offen lds
    s_add_u32 s43, s44, 48128
    s_mov_b32 m0, 60416
    s_nop 0
    buffer_load_dwordx4 v2, s[12:15], s43 offen lds
k2_kernel_ipd1:
    buffer_load_dwordx4 v[136:139], v2, s[8:11], s36 offen offset:2048
    buffer_load_dwordx4 v[140:143], v2, s[8:11], s36 offen offset:3072
    s_add_u32 s36, s36, 4096
    buffer_load_dwordx4 v[144:147], v2, s[8:11], s36 offen offset:0
    buffer_load_dwordx4 v[148:151], v2, s[8:11], s36 offen offset:1024
    buffer_load_dwordx4 v[152:155], v2, s[8:11], s36 offen offset:2048
    buffer_load_dwordx4 v[156:159], v2, s[8:11], s36 offen offset:3072
    s_waitcnt vmcnt(13)
    s_barrier
    ds_read_b128 v[32:35], v2 offset:0
    ds_read_b128 v[36:39], v2 offset:1024
    ds_read_b128 v[40:43], v2 offset:2048
    ds_read_b128 v[44:47], v2 offset:3072
    ds_read_b128 v[48:51], v2 offset:4096
    ds_read_b128 v[52:55], v2 offset:5120
    ds_read_b128 v[56:59], v2 offset:6144
    ds_read_b128 v[60:63], v2 offset:7168
    ds_read_b128 v[64:67], v2 offset:8192
    ds_read_b128 v[68:71], v2 offset:9216
    s_waitcnt lgkmcnt(5)
    v_mfma_f32_16x16x32_bf16 v[8:11], v[32:35], v[112:115], 0
    v_mfma_f32_16x16x32_bf16 v[12:15], v[36:39], v[112:115], 0
    v_mfma_f32_16x16x32_bf16 v[16:19], v[40:43], v[112:115], 0
    v_mfma_f32_16x16x32_bf16 v[20:23], v[44:47], v[112:115], 0
    v_mfma_f32_16x16x32_bf16 v[24:27], v[48:51], v[112:115], 0
    ds_read_b128 v[32:35], v2 offset:10240
    ds_read_b128 v[36:39], v2 offset:11264
    ds_read_b128 v[40:43], v2 offset:12288
    ds_read_b128 v[44:47], v2 offset:13312
    ds_read_b128 v[48:51], v2 offset:14336
    s_waitcnt lgkmcnt(5)
    v_mfma_f32_16x16x32_bf16 v[8:11], v[52:55], v[116:119], v[8:11]
    v_mfma_f32_16x16x32_bf16 v[12:15], v[56:59], v[116:119], v[12:15]
    v_mfma_f32_16x16x32_bf16 v[16:19], v[60:63], v[116:119], v[16:19]
    v_mfma_f32_16x16x32_bf16 v[20:23], v[64:67], v[116:119], v[20:23]
    v_mfma_f32_16x16x32_bf16 v[24:27], v[68:71], v[116:119], v[24:27]
    ds_read_b128 v[52:55], v2 offset:15360
    ds_read_b128 v[56:59], v2 offset:16384
    ds_read_b128 v[60:63], v2 offset:17408
    ds_read_b128 v[64:67], v2 offset:18432
    ds_read_b128 v[68:71], v2 offset:19456
    s_waitcnt lgkmcnt(5)
    v_mfma_f32_16x16x32_bf16 v[8:11], v[32:35], v[120:123], v[8:11]
    v_mfma_f32_16x16x32_bf16 v[12:15], v[36:39], v[120:123], v[12:15]
    v_mfma_f32_16x16x32_bf16 v[16:19], v[40:43], v[120:123], v[16:19]
    v_mfma_f32_16x16x32_bf16 v[20:23], v[44:47], v[120:123], v[20:23]
    v_mfma_f32_16x16x32_bf16 v[24:27], v[48:51], v[120:123], v[24:27]
    ds_read_b128 v[32:35], v2 offset:20480
    ds_read_b128 v[36:39], v2 offset:21504
    ds_read_b128 v[40:43], v2 offset:22528
    ds_read_b128 v[44:47], v2 offset:23552
    ds_read_b128 v[48:51], v2 offset:24576
    s_waitcnt lgkmcnt(5)
    v_mfma_f32_16x16x32_bf16 v[8:11], v[52:55], v[124:127], v[8:11]
    v_mfma_f32_16x16x32_bf16 v[12:15], v[56:59], v[124:127], v[12:15]
    v_mfma_f32_16x16x32_bf16 v[16:19], v[60:63], v[124:127], v[16:19]
    v_mfma_f32_16x16x32_bf16 v[20:23], v[64:67], v[124:127], v[20:23]
    v_mfma_f32_16x16x32_bf16 v[24:27], v[68:71], v[124:127], v[24:27]
    ds_read_b128 v[52:55], v2 offset:25600
    ds_read_b128 v[56:59], v2 offset:26624
    ds_read_b128 v[60:63], v2 offset:27648
    ds_read_b128 v[64:67], v2 offset:28672
    ds_read_b128 v[68:71], v2 offset:29696
    s_waitcnt lgkmcnt(5)
    v_mfma_f32_16x16x32_bf16 v[8:11], v[32:35], v[128:131], v[8:11]
    v_mfma_f32_16x16x32_bf16 v[12:15], v[36:39], v[128:131], v[12:15]
    v_mfma_f32_16x16x32_bf16 v[16:19], v[40:43], v[128:131], v[16:19]
    v_mfma_f32_16x16x32_bf16 v[20:23], v[44:47], v[128:131], v[20:23]
    v_mfma_f32_16x16x32_bf16 v[24:27], v[48:51], v[128:131], v[24:27]
    s_waitcnt lgkmcnt(0)
    v_mfma_f32_16x16x32_bf16 v[8:11], v[52:55], v[132:135], v[8:11]
    v_mfma_f32_16x16x32_bf16 v[12:15], v[56:59], v[132:135], v[12:15]
    v_mfma_f32_16x16x32_bf16 v[16:19], v[60:63], v[132:135], v[16:19]
    v_mfma_f32_16x16x32_bf16 v[20:23], v[64:67], v[132:135], v[20:23]
    v_mfma_f32_16x16x32_bf16 v[24:27], v[68:71], v[132:135], v[24:27]
    s_cmp_lg_u32 s28, 0
    s_cbranch_scc1 k2_kernel_ip2_1
    s_add_u32 s43, s44, 12288
    s_mov_b32 m0, 65536
    s_nop 0
    buffer_load_dwordx4 v2, s[12:15], s43 offen lds
    s_add_u32 s43, s44, 86016
    s_add_u32 s43, s43, s49
    s_mov_b32 m0, 69632
    s_nop 0
    buffer_load_dwordx4 v2, s[12:15], s43 offen lds
    s_add_u32 s43, s44, 68608
    s_mov_b32 m0, 73728
    s_nop 0
    buffer_load_dwordx4 v2, s[12:15], s43 offen lds
    s_add_u32 s43, s44, 51200
    s_mov_b32 m0, 77824
    s_nop 0
    buffer_load_dwordx4 v2, s[12:15], s43 offen lds
    s_add_u32 s43, s44, 33792
    s_mov_b32 m0, 81920
    s_nop 0
    buffer_load_dwordx4 v2, s[12:15], s43 offen lds
    s_add_u32 s43, s44, 16384
    s_mov_b32 m0, 86016
    s_nop 0
    buffer_load_dwordx4 v2, s[12:15], s43 offen lds
    s_add_u32 s43, s44, 90112
    s_add_u32 s43, s43, s49
    s_mov_b32 m0, 90112
    s_nop 0
    buffer_load_dwordx4 v2, s[12:15], s43 offen lds
    s_add_u32 s43, s44, 72704
    s_mov_b32 m0, 94208
    s_nop 0
    buffer_load_dwordx4 v2, s[12:15], s43 offen lds
    s_branch k2_kernel_ipd2
k2_kernel_ip2_1:
    s_cmp_lg_u32 s28, 1
    s_cbranch_scc1 k2_kernel_ip2_2
    s_add_u32 s43, s44, 30720
    s_mov_b32 m0, 66560
    s_nop 0
    buffer_load_dwordx4 v2, s[12:15], s43 offen lds
    s_add_u32 s43, s44, 13312
    s_mov_b32 m0, 70656
    s_nop 0
    buffer_load_dwordx4 v2, s[12:15], s43 offen lds
    s_add_u32 s43, s44, 87040
    s_add_u32 s43, s43, s49
    s_mov_b32 m0, 74752
    s_nop 0
    buffer_load_dwordx4 v2, s[12:15], s43 offen lds
    s_add_u32 s43, s44, 69632
    s_mov_b32 m0, 78848
    s_nop 0
    buffer_load_dwordx4 v2, s[12:15], s43 offen lds
    s_add_u32 s43, s44, 52224
    s_mov_b32 m0, 82944
    s_nop 0
    buffer_load_dwordx4 v2, s[12:15], s43 offen lds
    s_add_u32 s43, s44, 34816
    s_mov_b32 m0, 87040
    s_nop 0
    buffer_load_dwordx4 v2, s[12:15], s43 offen lds
    s_add_u32 s43, s44, 17408
    s_mov_b32 m0, 91136
    s_nop 0
    buffer_load_dwordx4 v2, s[12:15], s43 offen lds
    s_add_u32 s43, s44, 91136
    s_add_u32 s43, s43, s49
    s_mov_b32 m0, 95232
    s_nop 0
    buffer_load_dwordx4 v2, s[12:15], s43 offen lds
    s_branch k2_kernel_ipd2
k2_kernel_ip2_2:
    s_cmp_lg_u32 s28, 2
    s_cbranch_scc1 k2_kernel_ip2_3
    s_add_u32 s43, s44, 49152
    s_mov_b32 m0, 67584
    s_nop 0
    buffer_load_dwordx4 v2, s[12:15], s43 offen lds
    s_add_u32 s43, s44, 31744
    s_mov_b32 m0, 71680
    s_nop 0
    buffer_load_dwordx4 v2, s[12:15], s43 offen lds
    s_add_u32 s43, s44, 14336
    s_mov_b32 m0, 75776
    s_nop 0
    buffer_load_dwordx4 v2, s[12:15], s43 offen lds
    s_add_u32 s43, s44, 88064
    s_add_u32 s43, s43, s49
    s_mov_b32 m0, 79872
    s_nop 0
    buffer_load_dwordx4 v2, s[12:15], s43 offen lds
    s_add_u32 s43, s44, 70656
    s_mov_b32 m0, 83968
    s_nop 0
    buffer_load_dwordx4 v2, s[12:15], s43 offen lds
    s_add_u32 s43, s44, 53248
    s_mov_b32 m0, 88064
    s_nop 0
    buffer_load_dwordx4 v2, s[12:15], s43 offen lds
    s_add_u32 s43, s44, 35840
    s_mov_b32 m0, 92160
    s_nop 0
    buffer_load_dwordx4 v2, s[12:15], s43 offen lds
    s_branch k2_kernel_ipd2
k2_kernel_ip2_3:
    s_add_u32 s43, s44, 67584
    s_mov_b32 m0, 68608
    s_nop 0
    buffer_load_dwordx4 v2, s[12:15], s43 offen lds
    s_add_u32 s43, s44, 50176
    s_mov_b32 m0, 72704
    s_nop 0
    buffer_load_dwordx4 v2, s[12:15], s43 offen lds
    s_add_u32 s43, s44, 32768
    s_mov_b32 m0, 76800
    s_nop 0
    buffer_load_dwordx4 v2, s[12:15], s43 offen lds
    s_add_u32 s43, s44, 15360
    s_mov_b32 m0, 80896
    s_nop 0
    buffer_load_dwordx4 v2, s[12:15], s43 offen lds
    s_add_u32 s43, s44, 89088
    s_add_u32 s43, s43, s49
    s_mov_b32 m0, 84992
    s_nop 0
    buffer_load_dwordx4 v2, s[12:15], s43 offen lds
    s_add_u32 s43, s44, 71680
    s_mov_b32 m0, 89088
    s_nop 0
    buffer_load_dwordx4 v2, s[12:15], s43 offen lds
    s_add_u32 s43, s44, 54272
    s_mov_b32 m0, 93184
    s_nop 0
    buffer_load_dwordx4 v2, s[12:15], s43 offen lds
k2_kernel_ipd2:
    s_add_u32 s36, s36, 4096
    buffer_load_dwordx4 v[160:163], v2, s[8:11], s36 offen offset:0
    buffer_load_dwordx4 v[164:167], v2, s[8:11], s36 offen offset:1024
    buffer_load_dwordx4 v[168:171], v2, s[8:11], s36 offen offset:2048
    buffer_load_dwordx4 v[172:175], v2, s[8:11], s36 offen offset:3072
    s_add_u32 s36, s36, 4096
    buffer_load_dwordx4 v[176:179], v2, s[8:11], s36 offen offset:0
    buffer_load_dwordx4 v[180:183], v2, s[8:11], s36 offen offset:1024
    s_mov_b32 s16, s6
    s_mov_b32 s17, s7
    s_mov_b32 s18, 0x240000
    s_mov_b32 s19, 0x00020000
    v_and_b32 v3, 15, v1
    v_lshrrev_b32 v4, 4, v1
    s_lshl_b32 s37, s30, 6
    s_lshl_b32 s38, s28, 4
    s_add_u32 s42, s37, s38
    v_add_u32 v5, s42, v3
    v_mul_u32_u24 v5, 1152, v5
    v_lshl_add_u32 v5, v4, 3, v5
    s_lshl_b32 s37, s35, 5
    buffer_load_dwordx2 v[88:89], v5, s[16:19], s37 offen offset:0
    buffer_load_dwordx2 v[90:91], v5, s[16:19], s37 offen offset:32
    buffer_load_dwordx2 v[92:93], v5, s[16:19], s37 offen offset:64
    buffer_load_dwordx2 v[94:95], v5, s[16:19], s37 offen offset:96
    s_add_u32 s37, s37, s49
    buffer_load_dwordx2 v[96:97], v5, s[16:19], s37 offen offset:128
    s_cmp_ge_u32 s2, 72
    s_cbranch_scc1 k2_kernel_noaug
    s_add_u32 s56, s4, 0xddfa000
    s_addc_u32 s57, s5, 0
    s_mov_b32 s58, 0x51000
    s_mov_b32 s59, 0x00020000
    s_mov_b32 s60, s54
    s_mov_b32 s61, s55
    s_mov_b32 s62, 0x2400
    s_mov_b32 s63, 0x00020000
    s_lshl_b32 s39, s2, 2
    s_add_u32 s39, s39, s28
    v_and_b32 v100, 15, v1
    v_lshrrev_b32 v101, 4, v1
    v_mul_u32_u24 v101, 18432, v101
    v_lshl_add_u32 v101, v100, 2, v101
    s_lshl_b32 s40, s39, 6
    buffer_load_dword v102, v101, s[56:59], s40 offen
    s_add_u32 s40, s40, 73728
    buffer_load_dword v103, v101, s[56:59], s40 offen
    s_add_u32 s40, s40, 73728
    buffer_load_dword v104, v101, s[56:59], s40 offen
    s_add_u32 s40, s40, 73728
    buffer_load_dword v105, v101, s[56:59], s40 offen
    s_add_u32 s40, s40, 73728
    buffer_load_dword v106, v101, s[56:59], s40 offen
    v_lshlrev_b32 v100, 1, v100
    s_lshl_b32 s40, s39, 5
    buffer_load_ushort v107, v100, s[60:63], s40 offen
k2_kernel_noaug:
    s_waitcnt vmcnt(18)
    s_barrier
    ds_read_b128 v[32:35], v6 offset:0
    ds_read_b128 v[36:39], v6 offset:1024
    ds_read_b128 v[40:43], v6 offset:2048
    ds_read_b128 v[44:47], v6 offset:3072
    ds_read_b128 v[48:51], v6 offset:4096
    ds_read_b128 v[52:55], v6 offset:5120
    ds_read_b128 v[56:59], v6 offset:6144
    ds_read_b128 v[60:63], v6 offset:7168
    ds_read_b128 v[64:67], v6 offset:8192
    ds_read_b128 v[68:71], v6 offset:9216
    s_waitcnt lgkmcnt(5)
    v_mfma_f32_16x16x32_bf16 v[8:11], v[32:35], v[136:139], v[8:11]
    v_mfma_f32_16x16x32_bf16 v[12:15], v[36:39], v[136:139], v[12:15]
    v_mfma_f32_16x16x32_bf16 v[16:19], v[40:43], v[136:139], v[16:19]
    v_mfma_f32_16x16x32_bf16 v[20:23], v[44:47], v[136:139], v[20:23]
    v_mfma_f32_16x16x32_bf16 v[24:27], v[48:51], v[136:139], v[24:27]
    ds_read_b128 v[32:35], v6 offset:10240
    ds_read_b128 v[36:39], v6 offset:11264
    ds_read_b128 v[40:43], v6 offset:12288
    ds_read_b128 v[44:47], v6 offset:13312
    ds_read_b128 v[48:51], v6 offset:14336
    s_waitcnt lgkmcnt(5)
    v_mfma_f32_16x16x32_bf16 v[8:11], v[52:55], v[140:143], v[8:11]
    v_mfma_f32_16x16x32_bf16 v[12:15], v[56:59], v[140:143], v[12:15]
    v_mfma_f32_16x16x32_bf16 v[16:19], v[60:63], v[140:143], v[16:19]
    v_mfma_f32_16x16x32_bf16 v[20:23], v[64:67], v[140:143], v[20:23]
    v_mfma_f32_16x16x32_bf16 v[24:27], v[68:71], v[140:143], v[24:27]
    ds_read_b128 v[52:55], v6 offset:15360
    ds_read_b128 v[56:59], v6 offset:16384
    ds_read_b128 v[60:63], v6 offset:17408
    ds_read_b128 v[64:67], v6 offset:18432
    ds_read_b128 v[68:71], v6 offset:19456
    s_waitcnt lgkmcnt(5)
    v_mfma_f32_16x16x32_bf16 v[8:11], v[32:35], v[144:147], v[8:11]
    v_mfma_f32_16x16x32_bf16 v[12:15], v[36:39], v[144:147], v[12:15]
    v_mfma_f32_16x16x32_bf16 v[16:19], v[40:43], v[144:147], v[16:19]
    v_mfma_f32_16x16x32_bf16 v[20:23], v[44:47], v[144:147], v[20:23]
    v_mfma_f32_16x16x32_bf16 v[24:27], v[48:51], v[144:147], v[24:27]
    ds_read_b128 v[32:35], v6 offset:20480
    ds_read_b128 v[36:39], v6 offset:21504
    ds_read_b128 v[40:43], v6 offset:22528
    ds_read_b128 v[44:47], v6 offset:23552
    ds_read_b128 v[48:51], v6 offset:24576
    s_waitcnt lgkmcnt(5)
    v_mfma_f32_16x16x32_bf16 v[8:11], v[52:55], v[148:151], v[8:11]
    v_mfma_f32_16x16x32_bf16 v[12:15], v[56:59], v[148:151], v[12:15]
    v_mfma_f32_16x16x32_bf16 v[16:19], v[60:63], v[148:151], v[16:19]
    v_mfma_f32_16x16x32_bf16 v[20:23], v[64:67], v[148:151], v[20:23]
    v_mfma_f32_16x16x32_bf16 v[24:27], v[68:71], v[148:151], v[24:27]
    ds_read_b128 v[52:55], v6 offset:25600
    ds_read_b128 v[56:59], v6 offset:26624
    ds_read_b128 v[60:63], v6 offset:27648
    ds_read_b128 v[64:67], v6 offset:28672
    ds_read_b128 v[68:71], v6 offset:29696
    s_waitcnt lgkmcnt(5)
    v_mfma_f32_16x16x32_bf16 v[8:11], v[32:35], v[152:155], v[8:11]
    v_mfma_f32_16x16x32_bf16 v[12:15], v[36:39], v[152:155], v[12:15]
    v_mfma_f32_16x16x32_bf16 v[16:19], v[40:43], v[152:155], v[16:19]
    v_mfma_f32_16x16x32_bf16 v[20:23], v[44:47], v[152:155], v[20:23]
    v_mfma_f32_16x16x32_bf16 v[24:27], v[48:51], v[152:155], v[24:27]
    s_waitcnt lgkmcnt(0)
    v_mfma_f32_16x16x32_bf16 v[8:11], v[52:55], v[156:159], v[8:11]
    v_mfma_f32_16x16x32_bf16 v[12:15], v[56:59], v[156:159], v[12:15]
    v_mfma_f32_16x16x32_bf16 v[16:19], v[60:63], v[156:159], v[16:19]
    v_mfma_f32_16x16x32_bf16 v[20:23], v[64:67], v[156:159], v[20:23]
    v_mfma_f32_16x16x32_bf16 v[24:27], v[68:71], v[156:159], v[24:27]
    s_waitcnt vmcnt(5)
    s_barrier
    ds_read_b128 v[32:35], v7 offset:0
    ds_read_b128 v[36:39], v7 offset:1024
    ds_read_b128 v[40:43], v7 offset:2048
    ds_read_b128 v[44:47], v7 offset:3072
    ds_read_b128 v[48:51], v7 offset:4096
    ds_read_b128 v[52:55], v7 offset:5120
    ds_read_b128 v[56:59], v7 offset:6144
    ds_read_b128 v[60:63], v7 offset:7168
    ds_read_b128 v[64:67], v7 offset:8192
    ds_read_b128 v[68:71], v7 offset:9216
    s_waitcnt lgkmcnt(5)
    v_mfma_f32_16x16x32_bf16 v[8:11], v[32:35], v[160:163], v[8:11]
    v_mfma_f32_16x16x32_bf16 v[12:15], v[36:39], v[160:163], v[12:15]
    v_mfma_f32_16x16x32_bf16 v[16:19], v[40:43], v[160:163], v[16:19]
    v_mfma_f32_16x16x32_bf16 v[20:23], v[44:47], v[160:163], v[20:23]
    v_mfma_f32_16x16x32_bf16 v[24:27], v[48:51], v[160:163], v[24:27]
    ds_read_b128 v[32:35], v7 offset:10240
    ds_read_b128 v[36:39], v7 offset:11264
    ds_read_b128 v[40:43], v7 offset:12288
    ds_read_b128 v[44:47], v7 offset:13312
    ds_read_b128 v[48:51], v7 offset:14336
    s_waitcnt lgkmcnt(5)
    v_mfma_f32_16x16x32_bf16 v[8:11], v[52:55], v[164:167], v[8:11]
    v_mfma_f32_16x16x32_bf16 v[12:15], v[56:59], v[164:167], v[12:15]
    v_mfma_f32_16x16x32_bf16 v[16:19], v[60:63], v[164:167], v[16:19]
    v_mfma_f32_16x16x32_bf16 v[20:23], v[64:67], v[164:167], v[20:23]
    v_mfma_f32_16x16x32_bf16 v[24:27], v[68:71], v[164:167], v[24:27]
    ds_read_b128 v[52:55], v7 offset:15360
    ds_read_b128 v[56:59], v7 offset:16384
    ds_read_b128 v[60:63], v7 offset:17408
    ds_read_b128 v[64:67], v7 offset:18432
    ds_read_b128 v[68:71], v7 offset:19456
    s_waitcnt lgkmcnt(5)
    v_mfma_f32_16x16x32_bf16 v[8:11], v[32:35], v[168:171], v[8:11]
    v_mfma_f32_16x16x32_bf16 v[12:15], v[36:39], v[168:171], v[12:15]
    v_mfma_f32_16x16x32_bf16 v[16:19], v[40:43], v[168:171], v[16:19]
    v_mfma_f32_16x16x32_bf16 v[20:23], v[44:47], v[168:171], v[20:23]
    v_mfma_f32_16x16x32_bf16 v[24:27], v[48:51], v[168:171], v[24:27]
    ds_read_b128 v[32:35], v7 offset:20480
    ds_read_b128 v[36:39], v7 offset:21504
    ds_read_b128 v[40:43], v7 offset:22528
    ds_read_b128 v[44:47], v7 offset:23552
    ds_read_b128 v[48:51], v7 offset:24576
    s_waitcnt lgkmcnt(5)
    v_mfma_f32_16x16x32_bf16 v[8:11], v[52:55], v[172:175], v[8:11]
    v_mfma_f32_16x16x32_bf16 v[12:15], v[56:59], v[172:175], v[12:15]
    v_mfma_f32_16x16x32_bf16 v[16:19], v[60:63], v[172:175], v[16:19]
    v_mfma_f32_16x16x32_bf16 v[20:23], v[64:67], v[172:175], v[20:23]
    v_mfma_f32_16x16x32_bf16 v[24:27], v[68:71], v[172:175], v[24:27]
    ds_read_b128 v[52:55], v7 offset:25600
    ds_read_b128 v[56:59], v7 offset:26624
    ds_read_b128 v[60:63], v7 offset:27648
    ds_read_b128 v[64:67], v7 offset:28672
    ds_read_b128 v[68:71], v7 offset:29696
    s_waitcnt lgkmcnt(5)
    v_mfma_f32_16x16x32_bf16 v[8:11], v[32:35], v[176:179], v[8:11]
    v_mfma_f32_16x16x32_bf16 v[12:15], v[36:39], v[176:179], v[12:15]
    v_mfma_f32_16x16x32_bf16 v[16:19], v[40:43], v[176:179], v[16:19]
    v_mfma_f32_16x16x32_bf16 v[20:23], v[44:47], v[176:179], v[20:23]
    v_mfma_f32_16x16x32_bf16 v[24:27], v[48:51], v[176:179], v[24:27]
    s_waitcnt lgkmcnt(0)
    v_mfma_f32_16x16x32_bf16 v[8:11], v[52:55], v[180:183], v[8:11]
    v_mfma_f32_16x16x32_bf16 v[12:15], v[56:59], v[180:183], v[12:15]
    v_mfma_f32_16x16x32_bf16 v[16:19], v[60:63], v[180:183], v[16:19]
    v_mfma_f32_16x16x32_bf16 v[20:23], v[64:67], v[180:183], v[20:23]
    v_mfma_f32_16x16x32_bf16 v[24:27], v[68:71], v[180:183], v[24:27]
    s_add_u32 s20, s4, 0xdb7a000
    s_addc_u32 s21, s5, 0
    s_mov_b32 s22, 0x240000
    s_mov_b32 s23, 0x00020000
    s_add_u32 s24, s4, 0xddba000
    s_addc_u32 s25, s5, 0
    s_mov_b32 s26, 0x40000
    s_mov_b32 s27, 0x00020000
    s_waitcnt vmcnt(0)
    s_cmp_ge_u32 s2, 72
    s_cbranch_scc1 k2_kernel_noaug2
    v_add_f32 v102, v102, v103
    v_add_f32 v102, v102, v104
    v_add_f32 v102, v102, v105
    v_add_f32 v102, v102, v106
    v_mov_b32 v103, v102
    s_nop 1
    v_permlane16_swap_b32 v102, v103
    v_add_f32 v102, v102, v103
    v_mov_b32 v103, v102
    s_nop 1
    v_permlane32_swap_b32 v102, v103
    v_add_f32 v102, v102, v103
    v_cvt_pk_bf16_f32 v104, v102, v102
    v_and_b32 v105, 0xffff0000, v104
    v_sub_f32 v105, v102, v105
    v_cvt_pk_bf16_f32 v105, v105, v105
    v_and_b32 v105, 0xffff, v105
    v_lshl_or_b32 v105, v107, 16, v105
    v_cmp_gt_u32 vcc, 16, v1
    v_mov_b32 v111, 0
    s_nop 0
    v_cndmask_b32 v108, 0, v104, vcc
    v_cndmask_b32 v109, 0, v105, vcc
    v_cndmask_b32 v110, 0, v107, vcc
    s_add_u32 s56, s4, 0xcd52000
    s_addc_u32 s57, s5, 0
    s_mov_b32 s58, 0x558000
    s_mov_b32 s59, 0x00020000
    s_mul_i32 s40, s39, 19456
    buffer_store_dwordx4 v[108:111], v2, s[56:59], s40 offen
k2_kernel_noaug2:
    v_mov_b32 v98, 0
    v_mov_b32 v99, 0
    v_mov_b32 v100, 0xffff0000
    s_lshl_b32 s46, s30, 2
    s_add_u32 s46, s46, s28
    s_mul_i32 s46, s46, 18
    v_lshlrev_b32 v44, 16, v88
    v_and_b32 v45, v100, v88
    v_lshlrev_b32 v46, 16, v89
    v_and_b32 v47, v100, v89
    s_add_u32 s47, s35, 0
    s_lshr_b32 s50, s47, 1
    s_add_u32 s50, s50, s46
    s_lshl_b32 s50, s50, 10
    s_and_b32 s47, s47, 1
    s_lshl_b32 s47, s47, 3
    s_add_u32 s50, s50, s47
    v_add_f32 v44, v44, v8
    v_add_f32 v45, v45, v9
    v_add_f32 v46, v46, v10
    v_add_f32 v47, v47, v11
    v_cvt_pk_bf16_f32 v48, v44, v45
    v_cvt_pk_bf16_f32 v49, v46, v47
    buffer_store_dwordx2 v[48:49], v2, s[20:23], s50 offen
    v_lshlrev_b32 v44, 16, v48
    v_and_b32 v45, v100, v48
    v_lshlrev_b32 v46, 16, v49
    v_and_b32 v47, v100, v49
    v_add_f32 v98, v98, v44
    v_fmac_f32 v99, v44, v44
    v_add_f32 v98, v98, v45
    v_fmac_f32 v99, v45, v45
    v_add_f32 v98, v98, v46
    v_fmac_f32 v99, v46, v46
    v_add_f32 v98, v98, v47
    v_fmac_f32 v99, v47, v47
    v_lshlrev_b32 v44, 16, v90
    v_and_b32 v45, v100, v90
    v_lshlrev_b32 v46, 16, v91
    v_and_b32 v47, v100, v91
    s_add_u32 s47, s35, 1
    s_lshr_b32 s50, s47, 1
    s_add_u32 s50, s50, s46
    s_lshl_b32 s50, s50, 10
    s_and_b32 s47, s47, 1
    s_lshl_b32 s47, s47, 3
    s_add_u32 s50, s50, s47
    v_add_f32 v44, v44, v12
    v_add_f32 v45, v45, v13
    v_add_f32 v46, v46, v14
    v_add_f32 v47, v47, v15
    v_cvt_pk_bf16_f32 v50, v44, v45
    v_cvt_pk_bf16_f32 v51, v46, v47
    buffer_store_dwordx2 v[50:51], v2, s[20:23], s50 offen
    v_lshlrev_b32 v44, 16, v50
    v_and_b32 v45, v100, v50
    v_lshlrev_b32 v46, 16, v51
    v_and_b32 v47, v100, v51
    v_add_f32 v98, v98, v44
    v_fmac_f32 v99, v44, v44
    v_add_f32 v98, v98, v45
    v_fmac_f32 v99, v45, v45
    v_add_f32 v98, v98, v46
    v_fmac_f32 v99, v46, v46
    v_add_f32 v98, v98, v47
    v_fmac_f32 v99, v47, v47
    v_lshlrev_b32 v44, 16, v92
    v_and_b32 v45, v100, v92
    v_lshlrev_b32 v46, 16, v93
    v_and_b32 v47, v100, v93
    s_add_u32 s47, s35, 2
    s_lshr_b32 s50, s47, 1
    s_add_u32 s50, s50, s46
    s_lshl_b32 s50, s50, 10
    s_and_b32 s47, s47, 1
    s_lshl_b32 s47, s47, 3
    s_add_u32 s50, s50, s47
    v_add_f32 v44, v44, v16
    v_add_f32 v45, v45, v17
    v_add_f32 v46, v46, v18
    v_add_f32 v47, v47, v19
    v_cvt_pk_bf16_f32 v52, v44, v45
    v_cvt_pk_bf16_f32 v53, v46, v47
    buffer_store_dwordx2 v[52:53], v2, s[20:23], s50 offen
    v_lshlrev_b32 v44, 16, v52
    v_and_b32 v45, v100, v52
    v_lshlrev_b32 v46, 16, v53
    v_and_b32 v47, v100, v53
    v_add_f32 v98, v98, v44
    v_fmac_f32 v99, v44, v44
    v_add_f32 v98, v98, v45
    v_fmac_f32 v99, v45, v45
    v_add_f32 v98, v98, v46
    v_fmac_f32 v99, v46, v46
    v_add_f32 v98, v98, v47
    v_fmac_f32 v99, v47, v47
    v_lshlrev_b32 v44, 16, v94
    v_and_b32 v45, v100, v94
    v_lshlrev_b32 v46, 16, v95
    v_and_b32 v47, v100, v95
    s_add_u32 s47, s35, 3
    s_lshr_b32 s50, s47, 1
    s_add_u32 s50, s50, s46
    s_lshl_b32 s50, s50, 10
    s_and_b32 s47, s47, 1
    s_lshl_b32 s47, s47, 3
    s_add_u32 s50, s50, s47
    v_add_f32 v44, v44, v20
    v_add_f32 v45, v45, v21
    v_add_f32 v46, v46, v22
    v_add_f32 v47, v47, v23
    v_cvt_pk_bf16_f32 v54, v44, v45
    v_cvt_pk_bf16_f32 v55, v46, v47
    buffer_store_dwordx2 v[54:55], v2, s[20:23], s50 offen
    v_lshlrev_b32 v44, 16, v54
    v_and_b32 v45, v100, v54
    v_lshlrev_b32 v46, 16, v55
    v_and_b32 v47, v100, v55
    v_add_f32 v98, v98, v44
    v_fmac_f32 v99, v44, v44
    v_add_f32 v98, v98, v45
    v_fmac_f32 v99, v45, v45
    v_add_f32 v98, v98, v46
    v_fmac_f32 v99, v46, v46
    v_add_f32 v98, v98, v47
    v_fmac_f32 v99, v47, v47
    s_cmp_lg_u32 s49, 0
    s_cbranch_scc1 k2_kernel_ep_done
    v_lshlrev_b32 v44, 16, v96
    v_and_b32 v45, v100, v96
    v_lshlrev_b32 v46, 16, v97
    v_and_b32 v47, v100, v97
    s_add_u32 s47, s35, 4
    s_lshr_b32 s50, s47, 1
    s_add_u32 s50, s50, s46
    s_lshl_b32 s50, s50, 10
    s_and_b32 s47, s47, 1
    s_lshl_b32 s47, s47, 3
    s_add_u32 s50, s50, s47
    v_add_f32 v44, v44, v24
    v_add_f32 v45, v45, v25
    v_add_f32 v46, v46, v26
    v_add_f32 v47, v47, v27
    v_cvt_pk_bf16_f32 v56, v44, v45
    v_cvt_pk_bf16_f32 v57, v46, v47
    buffer_store_dwordx2 v[56:57], v2, s[20:23], s50 offen
    v_lshlrev_b32 v44, 16, v56
    v_and_b32 v45, v100, v56
    v_lshlrev_b32 v46, 16, v57
    v_and_b32 v47, v100, v57
    v_add_f32 v98, v98, v44
    v_fmac_f32 v99, v44, v44
    v_add_f32 v98, v98, v45
    v_fmac_f32 v99, v45, v45
    v_add_f32 v98, v98, v46
    v_fmac_f32 v99, v46, v46
    v_add_f32 v98, v98, v47
    v_fmac_f32 v99, v47, v47
k2_kernel_ep_done:
    v_mov_b32 v101, v98
    s_nop 1
    v_permlane16_swap_b32 v98, v101
    v_add_f32 v98, v98, v101
    v_mov_b32 v101, v98
    s_nop 1
    v_permlane32_swap_b32 v98, v101
    v_add_f32 v98, v98, v101
    v_mov_b32 v101, v99
    s_nop 1
    v_permlane16_swap_b32 v99, v101
    v_add_f32 v99, v99, v101
    v_mov_b32 v101, v99
    s_nop 1
    v_permlane32_swap_b32 v99, v101
    v_add_f32 v99, v99, v101
    v_add_u32 v6, s42, v3
    v_lshlrev_b32 v6, 6, v6
    s_lshl_b32 s47, s29, 3
    s_mov_b64 exec, 0xffff
    buffer_store_dwordx2 v[98:99], v6, s[24:27], s47 offen
    s_mov_b64 exec, -1
    s_lshl_b32 s46, s32, 2
    s_add_u32 s46, s46, s28
    s_getpc_b64 s[56:57]
Lpc_k2:
    s_add_u32 s56, s56, k3_kernel-Lpc_k2
    s_addc_u32 s57, s57, 0
    s_mov_b32 s58, k3_kernel_end-k3_kernel
    s_mov_b32 s59, 0x00020000
    s_mul_i32 s60, s46, 1024
    buffer_load_dwordx4 v[112:115], v2, s[56:59], s60 offen
k2_kernel_done:
    s_endpgm

.globl k3_kernel
.p2align 8
.type k3_kernel,@function
k3_kernel:
    s_cmp_ge_u32 s2, 256
    s_cbranch_scc1 k3_kernel_done
    s_load_dwordx2 s[4:5], s[0:1], 88
    s_load_dwordx4 s[24:27], s[0:1], 64
    v_lshrrev_b32 v2, 6, v0
    v_and_b32 v1, 63, v0
    v_readfirstlane_b32 s28, v2
    s_and_b32 s29, s2, 1
    s_lshl_b32 s29, s29, 2
    s_bfe_u32 s31, s2, 0x20003
    s_add_u32 s29, s29, s31
    s_bfe_u32 s30, s2, 0x20001
    s_lshl_b32 s30, s30, 3
    s_lshr_b32 s31, s2, 5
    s_add_u32 s30, s30, s31
    v_lshlrev_b32 v2, 4, v1
    s_waitcnt lgkmcnt(0)
    s_add_u32 s12, s4, 0xcd52000
    s_addc_u32 s13, s5, 0
    s_mov_b32 s14, 0xa68000
    s_mov_b32 s15, 0x00020000
    s_add_u32 s16, s4, 0xddba000
    s_addc_u32 s17, s5, 0
    s_mov_b32 s18, 0x40000
    s_mov_b32 s19, 0x00020000
    v_and_b32 v3, 15, v1
    v_lshrrev_b32 v8, 4, v1
    s_lshl_b32 s35, s30, 6
    v_add_u32 v4, s35, v3
    v_lshlrev_b32 v4, 6, v4
    v_lshl_add_u32 v4, v8, 4, v4
    buffer_load_dwordx4 v[32:35], v4, s[16:19], 0 offen offset:0
    buffer_load_dwordx4 v[36:39], v4, s[16:19], 0 offen offset:1024
    buffer_load_dwordx4 v[40:43], v4, s[16:19], 0 offen offset:2048
    buffer_load_dwordx4 v[44:47], v4, s[16:19], 0 offen offset:3072
    s_add_u32 s8, s4, 0xdb7a000
    s_addc_u32 s9, s5, 0
    s_mov_b32 s10, 0x240000
    s_mov_b32 s11, 0x00020000
    s_lshl_b32 s33, s30, 2
    s_add_u32 s33, s33, s28
    s_mul_i32 s33, s33, 18432
    s_mul_i32 s34, s28, 18432
    s_add_u32 m0, s34, 0
    s_nop 0
    buffer_load_dwordx4 v2, s[8:11], s33 offen offset:0 lds
    buffer_load_dwordx4 v2, s[8:11], s33 offen offset:1024 lds
    buffer_load_dwordx4 v2, s[8:11], s33 offen offset:2048 lds
    buffer_load_dwordx4 v2, s[8:11], s33 offen offset:3072 lds
    s_add_u32 m0, s34, 4096
    s_add_u32 s33, s33, 4096
    buffer_load_dwordx4 v2, s[8:11], s33 offen offset:0 lds
    buffer_load_dwordx4 v2, s[8:11], s33 offen offset:1024 lds
    buffer_load_dwordx4 v2, s[8:11], s33 offen offset:2048 lds
    buffer_load_dwordx4 v2, s[8:11], s33 offen offset:3072 lds
    s_add_u32 m0, s34, 8192
    s_add_u32 s33, s33, 4096
    buffer_load_dwordx4 v2, s[8:11], s33 offen offset:0 lds
    buffer_load_dwordx4 v2, s[8:11], s33 offen offset:1024 lds
    buffer_load_dwordx4 v2, s[8:11], s33 offen offset:2048 lds
    buffer_load_dwordx4 v2, s[8:11], s33 offen offset:3072 lds
    s_add_u32 m0, s34, 12288
    s_add_u32 s33, s33, 4096
    buffer_load_dwordx4 v2, s[8:11], s33 offen offset:0 lds
    buffer_load_dwordx4 v2, s[8:11], s33 offen offset:1024 lds
    buffer_load_dwordx4 v2, s[8:11], s33 offen offset:2048 lds
    buffer_load_dwordx4 v2, s[8:11], s33 offen offset:3072 lds
    s_add_u32 m0, s34, 16384
    s_add_u32 s33, s33, 4096
    buffer_load_dwordx4 v2, s[8:11], s33 offen offset:0 lds
    buffer_load_dwordx4 v2, s[8:11], s33 offen offset:1024 lds
    s_mov_b32 s36, 0
    s_mul_i32 s37, s29, 36
    s_mul_i32 s38, s28, 9
    s_add_u32 s37, s37, s38
    s_mul_i32 s39, s37, 19456
    v_add_u32 v20, 4096, v2
    v_add_u32 v21, 8192, v2
    v_add_u32 v22, 12288, v2
    v_add_u32 v23, 16384, v2
    s_mov_b32 s31, s36
    s_mul_i32 s32, s37, 18432
    s_add_u32 s32, s32, 5602304
    s_mov_b32 s40, s39
    s_add_u32 s41, s32, 1024
    s_add_u32 s42, s39, 19456
    buffer_load_dwordx4 v[128:131], v2, s[12:15], s40 offen offset:0
    buffer_load_dwordx4 v[132:135], v2, s[12:15], s40 offen offset:1024
    buffer_load_dwordx4 v[136:139], v2, s[12:15], s40 offen offset:2048
    buffer_load_dwordx4 v[140:143], v2, s[12:15], s40 offen offset:3072
    buffer_load_dwordx4 v[144:147], v20, s[12:15], s40 offen offset:0
    buffer_load_dwordx4 v[148:151], v20, s[12:15], s40 offen offset:1024
    buffer_load_dwordx4 v[152:155], v20, s[12:15], s40 offen offset:2048
    buffer_load_dwordx4 v[156:159], v20, s[12:15], s40 offen offset:3072
    buffer_load_dwordx4 v[160:163], v21, s[12:15], s40 offen offset:0
    buffer_load_dwordx4 v[164:167], v21, s[12:15], s40 offen offset:1024
    buffer_load_dwordx4 v[168:171], v21, s[12:15], s40 offen offset:2048
    buffer_load_dwordx4 v[172:175], v21, s[12:15], s40 offen offset:3072
    buffer_load_dwordx4 v[176:179], v22, s[12:15], s40 offen offset:0
    buffer_load_dwordx4 v[180:183], v22, s[12:15], s40 offen offset:1024
    buffer_load_dwordx4 v[184:187], v22, s[12:15], s40 offen offset:2048
    buffer_load_dwordx4 v[188:191], v22, s[12:15], s40 offen offset:3072
    buffer_load_dwordx4 v[192:195], v23, s[12:15], s40 offen offset:0
    buffer_load_dwordx4 v[196:199], v23, s[12:15], s40 offen offset:1024
    buffer_load_dwordx4 v[200:203], v23, s[12:15], s40 offen offset:2048
    s_add_u32 s20, s4, 0xde4d000
    s_addc_u32 s21, s5, 0
    s_mov_b32 s22, 0x1200000
    s_mov_b32 s23, 0x00020000
    s_waitcnt vmcnt(37)
    s_mov_b32 s58, 0x3ae38e39
    v_cmp_gt_u32 s[66:67], 16, v1
    v_add_f32 v8, v32, v34
    v_add_f32 v10, v33, v35
    v_mov_b32 v9, v8
    s_nop 1
    v_permlane16_swap_b32 v8, v9
    v_add_f32 v8, v8, v9
    v_mov_b32 v9, v8
    s_nop 1
    v_permlane32_swap_b32 v8, v9
    v_add_f32 v8, v8, v9
    v_mov_b32 v9, v10
    s_nop 1
    v_permlane16_swap_b32 v10, v9
    v_add_f32 v10, v10, v9
    v_mov_b32 v9, v10
    s_nop 1
    v_permlane32_swap_b32 v10, v9
    v_add_f32 v10, v10, v9
    v_mul_f32 v8, s58, v8
    v_mul_f32 v10, s58, v10
    v_fma_f32 v10, -v8, v8, v10
    v_max_f32 v10, 0, v10
    v_add_f32 v10, 0x3727c5ac, v10
    v_rsq_f32 v92, v10
    s_nop 0
    v_mul_f32 v11, v10, v92
    v_mul_f32 v84, 0xc0135761, v92
    v_mul_f32 v12, v92, v92
    v_mul_f32 v12, v12, v92
    v_mul_f32 v88, 0xbdd2d3e8, v12
    v_sub_f32 v8, 0, v8
    v_cvt_pk_bf16_f32 v13, v8, v11
    v_lshlrev_b32 v14, 16, v13
    v_and_b32 v15, 0xffff0000, v13
    v_sub_f32 v14, v8, v14
    v_sub_f32 v15, v11, v15
    v_cvt_pk_bf16_f32 v14, v14, v15
    v_and_b32 v16, 0xffff, v13
    v_lshl_or_b32 v16, v14, 16, v16
    v_lshrrev_b32 v17, 16, v14
    v_cndmask_b32 v208, 0, v16, s[66:67]
    v_cndmask_b32 v209, 0, v13, s[66:67]
    v_cndmask_b32 v210, 0, v17, s[66:67]
    v_mov_b32 v211, 0
    v_add_f32 v8, v36, v38
    v_add_f32 v10, v37, v39
    v_mov_b32 v9, v8
    s_nop 1
    v_permlane16_swap_b32 v8, v9
    v_add_f32 v8, v8, v9
    v_mov_b32 v9, v8
    s_nop 1
    v_permlane32_swap_b32 v8, v9
    v_add_f32 v8, v8, v9
    v_mov_b32 v9, v10
    s_nop 1
    v_permlane16_swap_b32 v10, v9
    v_add_f32 v10, v10, v9
    v_mov_b32 v9, v10
    s_nop 1
    v_permlane32_swap_b32 v10, v9
    v_add_f32 v10, v10, v9
    v_mul_f32 v8, s58, v8
    v_mul_f32 v10, s58, v10
    v_fma_f32 v10, -v8, v8, v10
    v_max_f32 v10, 0, v10
    v_add_f32 v10, 0x3727c5ac, v10
    v_rsq_f32 v93, v10
    s_nop 0
    v_mul_f32 v11, v10, v93
    v_mul_f32 v85, 0xc0135761, v93
    v_mul_f32 v12, v93, v93
    v_mul_f32 v12, v12, v93
    v_mul_f32 v89, 0xbdd2d3e8, v12
    v_sub_f32 v8, 0, v8
    v_cvt_pk_bf16_f32 v13, v8, v11
    v_lshlrev_b32 v14, 16, v13
    v_and_b32 v15, 0xffff0000, v13
    v_sub_f32 v14, v8, v14
    v_sub_f32 v15, v11, v15
    v_cvt_pk_bf16_f32 v14, v14, v15
    v_and_b32 v16, 0xffff, v13
    v_lshl_or_b32 v16, v14, 16, v16
    v_lshrrev_b32 v17, 16, v14
    v_cndmask_b32 v212, 0, v16, s[66:67]
    v_cndmask_b32 v213, 0, v13, s[66:67]
    v_cndmask_b32 v214, 0, v17, s[66:67]
    v_mov_b32 v215, 0
    v_add_f32 v8, v40, v42
    v_add_f32 v10, v41, v43
    v_mov_b32 v9, v8
    s_nop 1
    v_permlane16_swap_b32 v8, v9
    v_add_f32 v8, v8, v9
    v_mov_b32 v9, v8
    s_nop 1
    v_permlane32_swap_b32 v8, v9
    v_add_f32 v8, v8, v9
    v_mov_b32 v9, v10
    s_nop 1
    v_permlane16_swap_b32 v10, v9
    v_add_f32 v10, v10, v9
    v_mov_b32 v9, v10
    s_nop 1
    v_permlane32_swap_b32 v10, v9
    v_add_f32 v10, v10, v9
    v_mul_f32 v8, s58, v8
    v_mul_f32 v10, s58, v10
    v_fma_f32 v10, -v8, v8, v10
    v_max_f32 v10, 0, v10
    v_add_f32 v10, 0x3727c5ac, v10
    v_rsq_f32 v94, v10
    s_nop 0
    v_mul_f32 v11, v10, v94
    v_mul_f32 v86, 0xc0135761, v94
    v_mul_f32 v12, v94, v94
    v_mul_f32 v12, v12, v94
    v_mul_f32 v90, 0xbdd2d3e8, v12
    v_sub_f32 v8, 0, v8
    v_cvt_pk_bf16_f32 v13, v8, v11
    v_lshlrev_b32 v14, 16, v13
    v_and_b32 v15, 0xffff0000, v13
    v_sub_f32 v14, v8, v14
    v_sub_f32 v15, v11, v15
    v_cvt_pk_bf16_f32 v14, v14, v15
    v_and_b32 v16, 0xffff, v13
    v_lshl_or_b32 v16, v14, 16, v16
    v_lshrrev_b32 v17, 16, v14
    v_cndmask_b32 v216, 0, v16, s[66:67]
    v_cndmask_b32 v217, 0, v13, s[66:67]
    v_cndmask_b32 v218, 0, v17, s[66:67]
    v_mov_b32 v219, 0
    v_add_f32 v8, v44, v46
    v_add_f32 v10, v45, v47
    v_mov_b32 v9, v8
    s_nop 1
    v_permlane16_swap_b32 v8, v9
    v_add_f32 v8, v8, v9
    v_mov_b32 v9, v8
    s_nop 1
    v_permlane32_swap_b32 v8, v9
    v_add_f32 v8, v8, v9
    v_mov_b32 v9, v10
    s_nop 1
    v_permlane16_swap_b32 v10, v9
    v_add_f32 v10, v10, v9
    v_mov_b32 v9, v10
    s_nop 1
    v_permlane32_swap_b32 v10, v9
    v_add_f32 v10, v10, v9
    v_mul_f32 v8, s58, v8
    v_mul_f32 v10, s58, v10
    v_fma_f32 v10, -v8, v8, v10
    v_max_f32 v10, 0, v10
    v_add_f32 v10, 0x3727c5ac, v10
    v_rsq_f32 v95, v10
    s_nop 0
    v_mul_f32 v11, v10, v95
    v_mul_f32 v87, 0xc0135761, v95
    v_mul_f32 v12, v95, v95
    v_mul_f32 v12, v12, v95
    v_mul_f32 v91, 0xbdd2d3e8, v12
    v_sub_f32 v8, 0, v8
    v_cvt_pk_bf16_f32 v13, v8, v11
    v_lshlrev_b32 v14, 16, v13
    v_and_b32 v15, 0xffff0000, v13
    v_sub_f32 v14, v8, v14
    v_sub_f32 v15, v11, v15
    v_cvt_pk_bf16_f32 v14, v14, v15
    v_and_b32 v16, 0xffff, v13
    v_lshl_or_b32 v16, v14, 16, v16
    v_lshrrev_b32 v17, 16, v14
    v_cndmask_b32 v220, 0, v16, s[66:67]
    v_cndmask_b32 v221, 0, v13, s[66:67]
    v_cndmask_b32 v222, 0, v17, s[66:67]
    v_mov_b32 v223, 0
    s_waitcnt vmcnt(19)
    s_barrier
    v_add_u32 v5, 0x8000, v2
    v_add_u32 v6, 0x10000, v2
    v_add_u32 v7, 73728, v2
    v_add_u32 v18, 0x8000, v7
    s_mov_b32 s59, s36
    s_lshr_b32 s60, s38, 1
    s_and_b32 s61, s28, 1
    s_lshl_b32 s59, s60, 12
    s_lshl_b32 s63, s61, 3
    s_add_u32 s59, s59, s63
    v_add_u32 v19, s59, v7
    s_add_u32 s60, s60, s61
    s_lshl_b32 s59, s60, 12
    s_xor_b32 s61, s61, 1
    s_lshl_b32 s61, s61, 3
    s_add_u32 s59, s59, s61
    v_add_u32 v17, s59, v7
    s_mov_b32 s43, 0
    s_cmp_lt_u32 s43, 8
    s_cselect_b32 s40, s42, s41
    s_add_u32 s42, s42, 19456
    s_add_u32 s43, s43, 1
    ds_read_b128 a[0:3], v2 offset:0
    ds_read_b128 a[4:7], v2 offset:18432
    ds_read_b128 a[8:11], v5 offset:4096
    ds_read_b128 a[12:15], v5 offset:22528
    ds_read_b128 a[16:19], v2 offset:1024
    ds_read_b128 a[20:23], v2 offset:19456
    ds_read_b128 a[24:27], v5 offset:5120
    ds_read_b128 a[28:31], v5 offset:23552
    ds_read_b128 a[32:35], v2 offset:2048
    ds_read_b128 a[36:39], v2 offset:20480
    ds_read_b128 a[40:43], v5 offset:6144
    ds_read_b128 a[44:47], v5 offset:24576
    s_waitcnt vmcnt(15)
    v_mfma_f32_16x16x32_bf16 v[96:99], v[128:131], v[208:211], 0
    v_mfma_f32_16x16x32_bf16 v[100:103], v[128:131], v[212:215], 0
    v_mfma_f32_16x16x32_bf16 v[104:107], v[128:131], v[216:219], 0
    v_mfma_f32_16x16x32_bf16 v[108:111], v[128:131], v[220:223], 0
    buffer_load_dwordx4 v[128:131], v2, s[12:15], s40 offen offset:0
    ds_read_b128 a[48:51], v2 offset:3072
    ds_read_b128 a[52:55], v2 offset:21504
    ds_read_b128 a[56:59], v5 offset:7168
    ds_read_b128 a[60:63], v5 offset:25600
    s_waitcnt lgkmcnt(12)
    v_mfma_f32_16x16x32_bf16 v[96:99], v[132:135], a[0:3], v[96:99]
    v_mfma_f32_16x16x32_bf16 v[100:103], v[132:135], a[4:7], v[100:103]
    v_mfma_f32_16x16x32_bf16 v[104:107], v[132:135], a[8:11], v[104:107]
    v_mfma_f32_16x16x32_bf16 v[108:111], v[132:135], a[12:15], v[108:111]
    buffer_load_dwordx4 v[132:135], v2, s[12:15], s40 offen offset:1024
    ds_read_b128 a[64:67], v2 offset:4096
    ds_read_b128 a[68:71], v2 offset:22528
    ds_read_b128 a[72:75], v5 offset:8192
    ds_read_b128 a[76:79], v5 offset:26624
    s_waitcnt lgkmcnt(12)
    v_mfma_f32_16x16x32_bf16 v[96:99], v[136:139], a[16:19], v[96:99]
    v_mfma_f32_16x16x32_bf16 v[100:103], v[136:139], a[20:23], v[100:103]
    v_mfma_f32_16x16x32_bf16 v[104:107], v[136:139], a[24:27], v[104:107]
    v_mfma_f32_16x16x32_bf16 v[108:111], v[136:139], a[28:31], v[108:111]
    buffer_load_dwordx4 v[136:139], v2, s[12:15], s40 offen offset:2048
    ds_read_b128 a[80:83], v2 offset:5120
    ds_read_b128 a[84:87], v2 offset:23552
    ds_read_b128 a[88:91], v5 offset:9216
    ds_read_b128 a[92:95], v5 offset:27648
    s_waitcnt lgkmcnt(12)
    v_mfma_f32_16x16x32_bf16 v[96:99], v[140:143], a[32:35], v[96:99]
    v_mfma_f32_16x16x32_bf16 v[100:103], v[140:143], a[36:39], v[100:103]
    v_mfma_f32_16x16x32_bf16 v[104:107], v[140:143], a[40:43], v[104:107]
    v_mfma_f32_16x16x32_bf16 v[108:111], v[140:143], a[44:47], v[108:111]
    buffer_load_dwordx4 v[140:143], v2, s[12:15], s40 offen offset:3072
    s_waitcnt vmcnt(15)
    ds_read_b128 a[96:99], v2 offset:6144
    ds_read_b128 a[100:103], v2 offset:24576
    ds_read_b128 a[104:107], v5 offset:10240
    ds_read_b128 a[108:111], v5 offset:28672
    s_waitcnt lgkmcnt(12)
    v_mfma_f32_16x16x32_bf16 v[96:99], v[144:147], a[48:51], v[96:99]
    v_mfma_f32_16x16x32_bf16 v[100:103], v[144:147], a[52:55], v[100:103]
    v_mfma_f32_16x16x32_bf16 v[104:107], v[144:147], a[56:59], v[104:107]
    v_mfma_f32_16x16x32_bf16 v[108:111], v[144:147], a[60:63], v[108:111]
    buffer_load_dwordx4 v[144:147], v20, s[12:15], s40 offen offset:0
    ds_read_b128 a[112:115], v2 offset:7168
    ds_read_b128 a[116:119], v2 offset:25600
    ds_read_b128 a[120:123], v5 offset:11264
    ds_read_b128 a[124:127], v5 offset:29696
    s_waitcnt lgkmcnt(12)
    v_mfma_f32_16x16x32_bf16 v[96:99], v[148:151], a[64:67], v[96:99]
    v_mfma_f32_16x16x32_bf16 v[100:103], v[148:151], a[68:71], v[100:103]
    v_mfma_f32_16x16x32_bf16 v[104:107], v[148:151], a[72:75], v[104:107]
    v_mfma_f32_16x16x32_bf16 v[108:111], v[148:151], a[76:79], v[108:111]
    buffer_load_dwordx4 v[148:151], v20, s[12:15], s40 offen offset:1024
    ds_read_b128 a[128:131], v2 offset:8192
    ds_read_b128 a[132:135], v2 offset:26624
    ds_read_b128 a[136:139], v5 offset:12288
    ds_read_b128 a[140:143], v5 offset:30720
    s_waitcnt lgkmcnt(12)
    v_mfma_f32_16x16x32_bf16 v[96:99], v[152:155], a[80:83], v[96:99]
    v_mfma_f32_16x16x32_bf16 v[100:103], v[152:155], a[84:87], v[100:103]
    v_mfma_f32_16x16x32_bf16 v[104:107], v[152:155], a[88:91], v[104:107]
    v_mfma_f32_16x16x32_bf16 v[108:111], v[152:155], a[92:95], v[108:111]
    buffer_load_dwordx4 v[152:155], v20, s[12:15], s40 offen offset:2048
    ds_read_b128 a[144:147], v2 offset:9216
    ds_read_b128 a[148:151], v2 offset:27648
    ds_read_b128 a[152:155], v5 offset:13312
    ds_read_b128 a[156:159], v5 offset:31744
    s_waitcnt lgkmcnt(12)
    v_mfma_f32_16x16x32_bf16 v[96:99], v[156:159], a[96:99], v[96:99]
    v_mfma_f32_16x16x32_bf16 v[100:103], v[156:159], a[100:103], v[100:103]
    v_mfma_f32_16x16x32_bf16 v[104:107], v[156:159], a[104:107], v[104:107]
    v_mfma_f32_16x16x32_bf16 v[108:111], v[156:159], a[108:111], v[108:111]
    buffer_load_dwordx4 v[156:159], v20, s[12:15], s40 offen offset:3072
    s_waitcnt vmcnt(15)
    ds_read_b128 a[160:163], v2 offset:10240
    ds_read_b128 a[164:167], v2 offset:28672
    ds_read_b128 a[168:171], v5 offset:14336
    ds_read_b128 a[172:175], v6 offset:0
    s_waitcnt lgkmcnt(12)
    v_mfma_f32_16x16x32_bf16 v[96:99], v[160:163], a[112:115], v[96:99]
    v_mfma_f32_16x16x32_bf16 v[100:103], v[160:163], a[116:119], v[100:103]
    v_mfma_f32_16x16x32_bf16 v[104:107], v[160:163], a[120:123], v[104:107]
    v_mfma_f32_16x16x32_bf16 v[108:111], v[160:163], a[124:127], v[108:111]
    buffer_load_dwordx4 v[160:163], v21, s[12:15], s40 offen offset:0
    ds_read_b128 a[176:179], v2 offset:11264
    ds_read_b128 a[180:183], v2 offset:29696
    ds_read_b128 a[184:187], v5 offset:15360
    ds_read_b128 a[188:191], v6 offset:1024
    s_waitcnt lgkmcnt(12)
    v_mfma_f32_16x16x32_bf16 v[96:99], v[164:167], a[128:131], v[96:99]
    v_mfma_f32_16x16x32_bf16 v[100:103], v[164:167], a[132:135], v[100:103]
    v_mfma_f32_16x16x32_bf16 v[104:107], v[164:167], a[136:139], v[104:107]
    v_mfma_f32_16x16x32_bf16 v[108:111], v[164:167], a[140:143], v[108:111]
    buffer_load_dwordx4 v[164:167], v21, s[12:15], s40 offen offset:1024
    ds_read_b128 a[192:195], v2 offset:12288
    ds_read_b128 a[196:199], v2 offset:30720
    ds_read_b128 a[200:203], v5 offset:16384
    ds_read_b128 a[204:207], v6 offset:2048
    s_waitcnt lgkmcnt(12)
    v_mfma_f32_16x16x32_bf16 v[96:99], v[168:171], a[144:147], v[96:99]
    v_mfma_f32_16x16x32_bf16 v[100:103], v[168:171], a[148:151], v[100:103]
    v_mfma_f32_16x16x32_bf16 v[104:107], v[168:171], a[152:155], v[104:107]
    v_mfma_f32_16x16x32_bf16 v[108:111], v[168:171], a[156:159], v[108:111]
    buffer_load_dwordx4 v[168:171], v21, s[12:15], s40 offen offset:2048
    ds_read_b128 a[208:211], v2 offset:13312
    ds_read_b128 a[212:215], v2 offset:31744
    ds_read_b128 a[216:219], v5 offset:17408
    ds_read_b128 a[220:223], v6 offset:3072
    s_waitcnt lgkmcnt(12)
    v_mfma_f32_16x16x32_bf16 v[96:99], v[172:175], a[160:163], v[96:99]
    v_mfma_f32_16x16x32_bf16 v[100:103], v[172:175], a[164:167], v[100:103]
    v_mfma_f32_16x16x32_bf16 v[104:107], v[172:175], a[168:171], v[104:107]
    v_mfma_f32_16x16x32_bf16 v[108:111], v[172:175], a[172:175], v[108:111]
    buffer_load_dwordx4 v[172:175], v21, s[12:15], s40 offen offset:3072
    s_waitcnt vmcnt(15)
    ds_read_b128 a[224:227], v2 offset:14336
    ds_read_b128 a[228:231], v5 offset:0
    ds_read_b128 a[232:235], v5 offset:18432
    ds_read_b128 a[236:239], v6 offset:4096
    s_waitcnt lgkmcnt(12)
    v_mfma_f32_16x16x32_bf16 v[96:99], v[176:179], a[176:179], v[96:99]
    v_mfma_f32_16x16x32_bf16 v[100:103], v[176:179], a[180:183], v[100:103]
    v_mfma_f32_16x16x32_bf16 v[104:107], v[176:179], a[184:187], v[104:107]
    v_mfma_f32_16x16x32_bf16 v[108:111], v[176:179], a[188:191], v[108:111]
    buffer_load_dwordx4 v[176:179], v22, s[12:15], s40 offen offset:0
    ds_read_b128 a[240:243], v2 offset:15360
    ds_read_b128 a[244:247], v5 offset:1024
    ds_read_b128 a[248:251], v5 offset:19456
    ds_read_b128 a[252:255], v6 offset:5120
    s_waitcnt lgkmcnt(12)
    v_mfma_f32_16x16x32_bf16 v[96:99], v[180:183], a[192:195], v[96:99]
    v_mfma_f32_16x16x32_bf16 v[100:103], v[180:183], a[196:199], v[100:103]
    v_mfma_f32_16x16x32_bf16 v[104:107], v[180:183], a[200:203], v[104:107]
    v_mfma_f32_16x16x32_bf16 v[108:111], v[180:183], a[204:207], v[108:111]
    buffer_load_dwordx4 v[180:183], v22, s[12:15], s40 offen offset:1024
    ds_read_b128 v[224:227], v2 offset:16384
    ds_read_b128 v[228:231], v5 offset:2048
    ds_read_b128 v[232:235], v5 offset:20480
    ds_read_b128 v[236:239], v6 offset:6144
    s_waitcnt lgkmcnt(12)
    v_mfma_f32_16x16x32_bf16 v[96:99], v[184:187], a[208:211], v[96:99]
    v_mfma_f32_16x16x32_bf16 v[100:103], v[184:187], a[212:215], v[100:103]
    v_mfma_f32_16x16x32_bf16 v[104:107], v[184:187], a[216:219], v[104:107]
    v_mfma_f32_16x16x32_bf16 v[108:111], v[184:187], a[220:223], v[108:111]
    buffer_load_dwordx4 v[184:187], v22, s[12:15], s40 offen offset:2048
    ds_read_b128 v[240:243], v2 offset:17408
    ds_read_b128 v[244:247], v5 offset:3072
    ds_read_b128 v[248:251], v5 offset:21504
    ds_read_b128 v[252:255], v6 offset:7168
    s_waitcnt lgkmcnt(12)
    v_mfma_f32_16x16x32_bf16 v[96:99], v[188:191], a[224:227], v[96:99]
    v_mfma_f32_16x16x32_bf16 v[100:103], v[188:191], a[228:231], v[100:103]
    v_mfma_f32_16x16x32_bf16 v[104:107], v[188:191], a[232:235], v[104:107]
    v_mfma_f32_16x16x32_bf16 v[108:111], v[188:191], a[236:239], v[108:111]
    buffer_load_dwordx4 v[188:191], v22, s[12:15], s40 offen offset:3072
    s_waitcnt vmcnt(16)
    s_waitcnt lgkmcnt(8)
    v_mfma_f32_16x16x32_bf16 v[96:99], v[192:195], a[240:243], v[96:99]
    v_mfma_f32_16x16x32_bf16 v[100:103], v[192:195], a[244:247], v[100:103]
    v_mfma_f32_16x16x32_bf16 v[104:107], v[192:195], a[248:251], v[104:107]
    v_mfma_f32_16x16x32_bf16 v[108:111], v[192:195], a[252:255], v[108:111]
    buffer_load_dwordx4 v[192:195], v23, s[12:15], s40 offen offset:0
    s_waitcnt lgkmcnt(4)
    v_mfma_f32_16x16x32_bf16 v[96:99], v[196:199], v[224:227], v[96:99]
    v_mfma_f32_16x16x32_bf16 v[100:103], v[196:199], v[228:231], v[100:103]
    v_mfma_f32_16x16x32_bf16 v[104:107], v[196:199], v[232:235], v[104:107]
    v_mfma_f32_16x16x32_bf16 v[108:111], v[196:199], v[236:239], v[108:111]
    buffer_load_dwordx4 v[196:199], v23, s[12:15], s40 offen offset:1024
    s_waitcnt lgkmcnt(0)
    v_mfma_f32_16x16x32_bf16 v[96:99], v[200:203], v[240:243], v[96:99]
    v_mfma_f32_16x16x32_bf16 v[100:103], v[200:203], v[244:247], v[100:103]
    v_mfma_f32_16x16x32_bf16 v[104:107], v[200:203], v[248:251], v[104:107]
    v_mfma_f32_16x16x32_bf16 v[108:111], v[200:203], v[252:255], v[108:111]
    buffer_load_dwordx4 v[200:203], v23, s[12:15], s40 offen offset:2048
k3_kernel_g1loop:
    s_cmp_lt_u32 s43, 8
    s_cselect_b32 s40, s42, s41
    s_add_u32 s42, s42, 19456
    s_add_u32 s43, s43, 1
    s_waitcnt vmcnt(15)
    v_mfma_f32_16x16x32_bf16 v[112:115], v[128:131], v[208:211], 0
    v_mfma_f32_16x16x32_bf16 v[116:119], v[128:131], v[212:215], 0
    v_mfma_f32_16x16x32_bf16 v[120:123], v[128:131], v[216:219], 0
    v_mul_f32 v32, v96, v96
    v_mul_f32 v33, v97, v97
    v_mfma_f32_16x16x32_bf16 v[124:127], v[128:131], v[220:223], 0
    buffer_load_dwordx4 v[128:131], v2, s[12:15], s40 offen offset:0
    v_mul_f32 v34, v98, v98
    v_mul_f32 v35, v99, v99
    v_mfma_f32_16x16x32_bf16 v[112:115], v[132:135], a[0:3], v[112:115]
    v_fma_f32 v32, v32, v88, v84
    v_fma_f32 v33, v33, v88, v84
    v_mfma_f32_16x16x32_bf16 v[116:119], v[132:135], a[4:7], v[116:119]
    v_fma_f32 v34, v34, v88, v84
    v_mfma_f32_16x16x32_bf16 v[120:123], v[132:135], a[8:11], v[120:123]
    v_fma_f32 v35, v35, v88, v84
    v_mul_f32 v32, v96, v32
    v_mfma_f32_16x16x32_bf16 v[124:127], v[132:135], a[12:15], v[124:127]
    buffer_load_dwordx4 v[132:135], v2, s[12:15], s40 offen offset:1024
    v_mul_f32 v33, v97, v33
    v_mul_f32 v34, v98, v34
    v_mfma_f32_16x16x32_bf16 v[112:115], v[136:139], a[16:19], v[112:115]
    v_mul_f32 v35, v99, v35
    v_exp_f32 v32, v32
    v_mfma_f32_16x16x32_bf16 v[116:119], v[136:139], a[20:23], v[116:119]
    v_exp_f32 v33, v33
    v_mfma_f32_16x16x32_bf16 v[120:123], v[136:139], a[24:27], v[120:123]
    v_exp_f32 v34, v34
    v_exp_f32 v35, v35
    v_mfma_f32_16x16x32_bf16 v[124:127], v[136:139], a[28:31], v[124:127]
    buffer_load_dwordx4 v[136:139], v2, s[12:15], s40 offen offset:2048
    v_add_f32 v32, 1.0, v32
    v_add_f32 v33, 1.0, v33
    v_mfma_f32_16x16x32_bf16 v[112:115], v[140:143], a[32:35], v[112:115]
    v_add_f32 v34, 1.0, v34
    v_mfma_f32_16x16x32_bf16 v[116:119], v[140:143], a[36:39], v[116:119]
    v_add_f32 v35, 1.0, v35
    v_rcp_f32 v32, v32
    v_mfma_f32_16x16x32_bf16 v[120:123], v[140:143], a[40:43], v[120:123]
    v_rcp_f32 v33, v33
    v_rcp_f32 v34, v34
    v_mfma_f32_16x16x32_bf16 v[124:127], v[140:143], a[44:47], v[124:127]
    buffer_load_dwordx4 v[140:143], v2, s[12:15], s40 offen offset:3072
    v_rcp_f32 v35, v35
    v_mul_f32 v36, v96, v32
    s_waitcnt vmcnt(15)
    v_mfma_f32_16x16x32_bf16 v[112:115], v[144:147], a[48:51], v[112:115]
    v_mul_f32 v37, v97, v33
    v_mfma_f32_16x16x32_bf16 v[116:119], v[144:147], a[52:55], v[116:119]
    v_mul_f32 v38, v98, v34
    v_mul_f32 v39, v99, v35
    v_mfma_f32_16x16x32_bf16 v[120:123], v[144:147], a[56:59], v[120:123]
    v_cvt_pk_bf16_f32 v48, v36, v37
    v_cvt_pk_bf16_f32 v49, v38, v39
    v_mfma_f32_16x16x32_bf16 v[124:127], v[144:147], a[60:63], v[124:127]
    buffer_load_dwordx4 v[144:147], v20, s[12:15], s40 offen offset:0
    ds_write_b64 v19, v[48:49] offset:0
    v_mfma_f32_16x16x32_bf16 v[112:115], v[148:151], a[64:67], v[112:115]
    v_mul_f32 v40, v100, v100
    v_mul_f32 v41, v101, v101
    v_mfma_f32_16x16x32_bf16 v[116:119], v[148:151], a[68:71], v[116:119]
    v_mul_f32 v42, v102, v102
    v_mul_f32 v43, v103, v103
    v_mfma_f32_16x16x32_bf16 v[120:123], v[148:151], a[72:75], v[120:123]
    v_fma_f32 v40, v40, v89, v85
    v_fma_f32 v41, v41, v89, v85
    v_mfma_f32_16x16x32_bf16 v[124:127], v[148:151], a[76:79], v[124:127]
    buffer_load_dwordx4 v[148:151], v20, s[12:15], s40 offen offset:1024
    v_fma_f32 v42, v42, v89, v85
    v_mfma_f32_16x16x32_bf16 v[112:115], v[152:155], a[80:83], v[112:115]
    v_fma_f32 v43, v43, v89, v85
    v_mul_f32 v40, v100, v40
    v_mfma_f32_16x16x32_bf16 v[116:119], v[152:155], a[84:87], v[116:119]
    v_mul_f32 v41, v101, v41
    v_mul_f32 v42, v102, v42
    v_mfma_f32_16x16x32_bf16 v[120:123], v[152:155], a[88:91], v[120:123]
    v_mul_f32 v43, v103, v43
    v_exp_f32 v40, v40
    v_mfma_f32_16x16x32_bf16 v[124:127], v[152:155], a[92:95], v[124:127]
    buffer_load_dwordx4 v[152:155], v20, s[12:15], s40 offen offset:2048
    v_exp_f32 v41, v41
    v_mfma_f32_16x16x32_bf16 v[112:115], v[156:159], a[96:99], v[112:115]
    v_exp_f32 v42, v42
    v_exp_f32 v43, v43
    v_mfma_f32_16x16x32_bf16 v[116:119], v[156:159], a[100:103], v[116:119]
    v_add_f32 v40, 1.0, v40
    v_add_f32 v41, 1.0, v41
    v_mfma_f32_16x16x32_bf16 v[120:123], v[156:159], a[104:107], v[120:123]
    v_add_f32 v42, 1.0, v42
    v_mfma_f32_16x16x32_bf16 v[124:127], v[156:159], a[108:111], v[124:127]
    buffer_load_dwordx4 v[156:159], v20, s[12:15], s40 offen offset:3072
    v_add_f32 v43, 1.0, v43
    v_rcp_f32 v40, v40
    s_waitcnt vmcnt(15)
    v_mfma_f32_16x16x32_bf16 v[112:115], v[160:163], a[112:115], v[112:115]
    v_rcp_f32 v41, v41
    v_rcp_f32 v42, v42
    v_mfma_f32_16x16x32_bf16 v[116:119], v[160:163], a[116:119], v[116:119]
    v_rcp_f32 v43, v43
    v_mul_f32 v44, v100, v40
    v_mfma_f32_16x16x32_bf16 v[120:123], v[160:163], a[120:123], v[120:123]
    v_mul_f32 v45, v101, v41
    v_mfma_f32_16x16x32_bf16 v[124:127], v[160:163], a[124:127], v[124:127]
    buffer_load_dwordx4 v[160:163], v21, s[12:15], s40 offen offset:0
    v_mul_f32 v46, v102, v42
    v_mul_f32 v47, v103, v43
    v_mfma_f32_16x16x32_bf16 v[112:115], v[164:167], a[128:131], v[112:115]
    v_cvt_pk_bf16_f32 v50, v44, v45
    v_cvt_pk_bf16_f32 v51, v46, v47
    v_mfma_f32_16x16x32_bf16 v[116:119], v[164:167], a[132:135], v[116:119]
    ds_write_b64 v19, v[50:51] offset:1024
    v_mfma_f32_16x16x32_bf16 v[120:123], v[164:167], a[136:139], v[120:123]
    v_mul_f32 v32, v104, v104
    v_mul_f32 v33, v105, v105
    v_mfma_f32_16x16x32_bf16 v[124:127], v[164:167], a[140:143], v[124:127]
    buffer_load_dwordx4 v[164:167], v21, s[12:15], s40 offen offset:1024
    v_mul_f32 v34, v106, v106
    v_mul_f32 v35, v107, v107
    v_mfma_f32_16x16x32_bf16 v[112:115], v[168:171], a[144:147], v[112:115]
    v_fma_f32 v32, v32, v90, v86
    v_fma_f32 v33, v33, v90, v86
    v_mfma_f32_16x16x32_bf16 v[116:119], v[168:171], a[148:151], v[116:119]
    v_fma_f32 v34, v34, v90, v86
    v_mfma_f32_16x16x32_bf16 v[120:123], v[168:171], a[152:155], v[120:123]
    v_fma_f32 v35, v35, v90, v86
    v_mul_f32 v32, v104, v32
    v_mfma_f32_16x16x32_bf16 v[124:127], v[168:171], a[156:159], v[124:127]
    buffer_load_dwordx4 v[168:171], v21, s[12:15], s40 offen offset:2048
    v_mul_f32 v33, v105, v33
    v_mul_f32 v34, v106, v34
    v_mfma_f32_16x16x32_bf16 v[112:115], v[172:175], a[160:163], v[112:115]
    v_mul_f32 v35, v107, v35
    v_exp_f32 v32, v32
    v_mfma_f32_16x16x32_bf16 v[116:119], v[172:175], a[164:167], v[116:119]
    v_exp_f32 v33, v33
    v_mfma_f32_16x16x32_bf16 v[120:123], v[172:175], a[168:171], v[120:123]
    v_exp_f32 v34, v34
    v_exp_f32 v35, v35
    v_mfma_f32_16x16x32_bf16 v[124:127], v[172:175], a[172:175], v[124:127]
    buffer_load_dwordx4 v[172:175], v21, s[12:15], s40 offen offset:3072
    v_add_f32 v32, 1.0, v32
    v_add_f32 v33, 1.0, v33
    s_waitcnt vmcnt(15)
    v_mfma_f32_16x16x32_bf16 v[112:115], v[176:179], a[176:179], v[112:115]
    v_add_f32 v34, 1.0, v34
    v_mfma_f32_16x16x32_bf16 v[116:119], v[176:179], a[180:183], v[116:119]
    v_add_f32 v35, 1.0, v35
    v_rcp_f32 v32, v32
    v_mfma_f32_16x16x32_bf16 v[120:123], v[176:179], a[184:187], v[120:123]
    v_rcp_f32 v33, v33
    v_rcp_f32 v34, v34
    v_mfma_f32_16x16x32_bf16 v[124:127], v[176:179], a[188:191], v[124:127]
    buffer_load_dwordx4 v[176:179], v22, s[12:15], s40 offen offset:0
    v_rcp_f32 v35, v35
    v_mul_f32 v36, v104, v32
    v_mfma_f32_16x16x32_bf16 v[112:115], v[180:183], a[192:195], v[112:115]
    v_mul_f32 v37, v105, v33
    v_mfma_f32_16x16x32_bf16 v[116:119], v[180:183], a[196:199], v[116:119]
    v_mul_f32 v38, v106, v34
    v_mul_f32 v39, v107, v35
    v_mfma_f32_16x16x32_bf16 v[120:123], v[180:183], a[200:203], v[120:123]
    v_cvt_pk_bf16_f32 v52, v36, v37
    v_cvt_pk_bf16_f32 v53, v38, v39
    v_mfma_f32_16x16x32_bf16 v[124:127], v[180:183], a[204:207], v[124:127]
    buffer_load_dwordx4 v[180:183], v22, s[12:15], s40 offen offset:1024
    ds_write_b64 v19, v[52:53] offset:2048
    v_mfma_f32_16x16x32_bf16 v[112:115], v[184:187], a[208:211], v[112:115]
    v_mul_f32 v40, v108, v108
    v_mul_f32 v41, v109, v109
    v_mfma_f32_16x16x32_bf16 v[116:119], v[184:187], a[212:215], v[116:119]
    v_mul_f32 v42, v110, v110
    v_mul_f32 v43, v111, v111
    v_mfma_f32_16x16x32_bf16 v[120:123], v[184:187], a[216:219], v[120:123]
    v_fma_f32 v40, v40, v91, v87
    v_fma_f32 v41, v41, v91, v87
    v_mfma_f32_16x16x32_bf16 v[124:127], v[184:187], a[220:223], v[124:127]
    buffer_load_dwordx4 v[184:187], v22, s[12:15], s40 offen offset:2048
    v_fma_f32 v42, v42, v91, v87
    v_mfma_f32_16x16x32_bf16 v[112:115], v[188:191], a[224:227], v[112:115]
    v_fma_f32 v43, v43, v91, v87
    v_mul_f32 v40, v108, v40
    v_mfma_f32_16x16x32_bf16 v[116:119], v[188:191], a[228:231], v[116:119]
    v_mul_f32 v41, v109, v41
    v_mul_f32 v42, v110, v42
    v_mfma_f32_16x16x32_bf16 v[120:123], v[188:191], a[232:235], v[120:123]
    v_mul_f32 v43, v111, v43
    v_exp_f32 v40, v40
    v_mfma_f32_16x16x32_bf16 v[124:127], v[188:191], a[236:239], v[124:127]
    buffer_load_dwordx4 v[188:191], v22, s[12:15], s40 offen offset:3072
    v_exp_f32 v41, v41
    s_waitcnt vmcnt(16)
    v_mfma_f32_16x16x32_bf16 v[112:115], v[192:195], a[240:243], v[112:115]
    v_exp_f32 v42, v42
    v_exp_f32 v43, v43
    v_mfma_f32_16x16x32_bf16 v[116:119], v[192:195], a[244:247], v[116:119]
    v_add_f32 v40, 1.0, v40
    v_add_f32 v41, 1.0, v41
    v_mfma_f32_16x16x32_bf16 v[120:123], v[192:195], a[248:251], v[120:123]
    v_add_f32 v42, 1.0, v42
    v_mfma_f32_16x16x32_bf16 v[124:127], v[192:195], a[252:255], v[124:127]
    buffer_load_dwordx4 v[192:195], v23, s[12:15], s40 offen offset:0
    v_add_f32 v43, 1.0, v43
    v_rcp_f32 v40, v40
    v_mfma_f32_16x16x32_bf16 v[112:115], v[196:199], v[224:227], v[112:115]
    v_rcp_f32 v41, v41
    v_rcp_f32 v42, v42
    v_mfma_f32_16x16x32_bf16 v[116:119], v[196:199], v[228:231], v[116:119]
    v_rcp_f32 v43, v43
    v_mul_f32 v44, v108, v40
    v_mfma_f32_16x16x32_bf16 v[120:123], v[196:199], v[232:235], v[120:123]
    v_mul_f32 v45, v109, v41
    v_mfma_f32_16x16x32_bf16 v[124:127], v[196:199], v[236:239], v[124:127]
    buffer_load_dwordx4 v[196:199], v23, s[12:15], s40 offen offset:1024
    v_mul_f32 v46, v110, v42
    v_mul_f32 v47, v111, v43
    v_mfma_f32_16x16x32_bf16 v[112:115], v[200:203], v[240:243], v[112:115]
    v_cvt_pk_bf16_f32 v54, v44, v45
    v_cvt_pk_bf16_f32 v55, v46, v47
    v_mfma_f32_16x16x32_bf16 v[116:119], v[200:203], v[244:247], v[116:119]
    ds_write_b64 v19, v[54:55] offset:3072
    v_mfma_f32_16x16x32_bf16 v[120:123], v[200:203], v[248:251], v[120:123]
    v_mfma_f32_16x16x32_bf16 v[124:127], v[200:203], v[252:255], v[124:127]
    buffer_load_dwordx4 v[200:203], v23, s[12:15], s40 offen offset:2048
    s_cmp_lt_u32 s43, 8
    s_cselect_b32 s40, s42, s41
    s_add_u32 s42, s42, 19456
    s_add_u32 s43, s43, 1
    s_waitcnt vmcnt(15)
    v_mfma_f32_16x16x32_bf16 v[96:99], v[128:131], v[208:211], 0
    v_mfma_f32_16x16x32_bf16 v[100:103], v[128:131], v[212:215], 0
    v_mfma_f32_16x16x32_bf16 v[104:107], v[128:131], v[216:219], 0
    v_mul_f32 v32, v112, v112
    v_mul_f32 v33, v113, v113
    v_mfma_f32_16x16x32_bf16 v[108:111], v[128:131], v[220:223], 0
    buffer_load_dwordx4 v[128:131], v2, s[12:15], s40 offen offset:0
    v_mul_f32 v34, v114, v114
    v_mul_f32 v35, v115, v115
    v_mfma_f32_16x16x32_bf16 v[96:99], v[132:135], a[0:3], v[96:99]
    v_fma_f32 v32, v32, v88, v84
    v_fma_f32 v33, v33, v88, v84
    v_mfma_f32_16x16x32_bf16 v[100:103], v[132:135], a[4:7], v[100:103]
    v_fma_f32 v34, v34, v88, v84
    v_mfma_f32_16x16x32_bf16 v[104:107], v[132:135], a[8:11], v[104:107]
    v_fma_f32 v35, v35, v88, v84
    v_mul_f32 v32, v112, v32
    v_mfma_f32_16x16x32_bf16 v[108:111], v[132:135], a[12:15], v[108:111]
    buffer_load_dwordx4 v[132:135], v2, s[12:15], s40 offen offset:1024
    v_mul_f32 v33, v113, v33
    v_mul_f32 v34, v114, v34
    v_mfma_f32_16x16x32_bf16 v[96:99], v[136:139], a[16:19], v[96:99]
    v_mul_f32 v35, v115, v35
    v_exp_f32 v32, v32
    v_mfma_f32_16x16x32_bf16 v[100:103], v[136:139], a[20:23], v[100:103]
    v_exp_f32 v33, v33
    v_mfma_f32_16x16x32_bf16 v[104:107], v[136:139], a[24:27], v[104:107]
    v_exp_f32 v34, v34
    v_exp_f32 v35, v35
    v_mfma_f32_16x16x32_bf16 v[108:111], v[136:139], a[28:31], v[108:111]
    buffer_load_dwordx4 v[136:139], v2, s[12:15], s40 offen offset:2048
    v_add_f32 v32, 1.0, v32
    v_add_f32 v33, 1.0, v33
    v_mfma_f32_16x16x32_bf16 v[96:99], v[140:143], a[32:35], v[96:99]
    v_add_f32 v34, 1.0, v34
    v_mfma_f32_16x16x32_bf16 v[100:103], v[140:143], a[36:39], v[100:103]
    v_add_f32 v35, 1.0, v35
    v_rcp_f32 v32, v32
    v_mfma_f32_16x16x32_bf16 v[104:107], v[140:143], a[40:43], v[104:107]
    v_rcp_f32 v33, v33
    v_rcp_f32 v34, v34
    v_mfma_f32_16x16x32_bf16 v[108:111], v[140:143], a[44:47], v[108:111]
    buffer_load_dwordx4 v[140:143], v2, s[12:15], s40 offen offset:3072
    v_rcp_f32 v35, v35
    v_mul_f32 v36, v112, v32
    s_waitcnt vmcnt(15)
    v_mfma_f32_16x16x32_bf16 v[96:99], v[144:147], a[48:51], v[96:99]
    v_mul_f32 v37, v113, v33
    v_mfma_f32_16x16x32_bf16 v[100:103], v[144:147], a[52:55], v[100:103]
    v_mul_f32 v38, v114, v34
    v_mul_f32 v39, v115, v35
    v_mfma_f32_16x16x32_bf16 v[104:107], v[144:147], a[56:59], v[104:107]
    v_cvt_pk_bf16_f32 v48, v36, v37
    v_cvt_pk_bf16_f32 v49, v38, v39
    v_mfma_f32_16x16x32_bf16 v[108:111], v[144:147], a[60:63], v[108:111]
    buffer_load_dwordx4 v[144:147], v20, s[12:15], s40 offen offset:0
    ds_write_b64 v17, v[48:49] offset:0
    v_mfma_f32_16x16x32_bf16 v[96:99], v[148:151], a[64:67], v[96:99]
    v_mul_f32 v40, v116, v116
    v_mul_f32 v41, v117, v117
    v_mfma_f32_16x16x32_bf16 v[100:103], v[148:151], a[68:71], v[100:103]
    v_mul_f32 v42, v118, v118
    v_mul_f32 v43, v119, v119
    v_mfma_f32_16x16x32_bf16 v[104:107], v[148:151], a[72:75], v[104:107]
    v_fma_f32 v40, v40, v89, v85
    v_fma_f32 v41, v41, v89, v85
    v_mfma_f32_16x16x32_bf16 v[108:111], v[148:151], a[76:79], v[108:111]
    buffer_load_dwordx4 v[148:151], v20, s[12:15], s40 offen offset:1024
    v_fma_f32 v42, v42, v89, v85
    v_mfma_f32_16x16x32_bf16 v[96:99], v[152:155], a[80:83], v[96:99]
    v_fma_f32 v43, v43, v89, v85
    v_mul_f32 v40, v116, v40
    v_mfma_f32_16x16x32_bf16 v[100:103], v[152:155], a[84:87], v[100:103]
    v_mul_f32 v41, v117, v41
    v_mul_f32 v42, v118, v42
    v_mfma_f32_16x16x32_bf16 v[104:107], v[152:155], a[88:91], v[104:107]
    v_mul_f32 v43, v119, v43
    v_exp_f32 v40, v40
    v_mfma_f32_16x16x32_bf16 v[108:111], v[152:155], a[92:95], v[108:111]
    buffer_load_dwordx4 v[152:155], v20, s[12:15], s40 offen offset:2048
    v_exp_f32 v41, v41
    v_mfma_f32_16x16x32_bf16 v[96:99], v[156:159], a[96:99], v[96:99]
    v_exp_f32 v42, v42
    v_exp_f32 v43, v43
    v_mfma_f32_16x16x32_bf16 v[100:103], v[156:159], a[100:103], v[100:103]
    v_add_f32 v40, 1.0, v40
    v_add_f32 v41, 1.0, v41
    v_mfma_f32_16x16x32_bf16 v[104:107], v[156:159], a[104:107], v[104:107]
    v_add_f32 v42, 1.0, v42
    v_mfma_f32_16x16x32_bf16 v[108:111], v[156:159], a[108:111], v[108:111]
    buffer_load_dwordx4 v[156:159], v20, s[12:15], s40 offen offset:3072
    v_add_f32 v43, 1.0, v43
    v_rcp_f32 v40, v40
    s_waitcnt vmcnt(15)
    v_mfma_f32_16x16x32_bf16 v[96:99], v[160:163], a[112:115], v[96:99]
    v_rcp_f32 v41, v41
    v_rcp_f32 v42, v42
    v_mfma_f32_16x16x32_bf16 v[100:103], v[160:163], a[116:119], v[100:103]
    v_rcp_f32 v43, v43
    v_mul_f32 v44, v116, v40
    v_mfma_f32_16x16x32_bf16 v[104:107], v[160:163], a[120:123], v[104:107]
    v_mul_f32 v45, v117, v41
    v_mfma_f32_16x16x32_bf16 v[108:111], v[160:163], a[124:127], v[108:111]
    buffer_load_dwordx4 v[160:163], v21, s[12:15], s40 offen offset:0
    v_mul_f32 v46, v118, v42
    v_mul_f32 v47, v119, v43
    v_mfma_f32_16x16x32_bf16 v[96:99], v[164:167], a[128:131], v[96:99]
    v_cvt_pk_bf16_f32 v50, v44, v45
    v_cvt_pk_bf16_f32 v51, v46, v47
    v_mfma_f32_16x16x32_bf16 v[100:103], v[164:167], a[132:135], v[100:103]
    ds_write_b64 v17, v[50:51] offset:1024
    v_mfma_f32_16x16x32_bf16 v[104:107], v[164:167], a[136:139], v[104:107]
    v_mul_f32 v32, v120, v120
    v_mul_f32 v33, v121, v121
    v_mfma_f32_16x16x32_bf16 v[108:111], v[164:167], a[140:143], v[108:111]
    buffer_load_dwordx4 v[164:167], v21, s[12:15], s40 offen offset:1024
    v_mul_f32 v34, v122, v122
    v_mul_f32 v35, v123, v123
    v_mfma_f32_16x16x32_bf16 v[96:99], v[168:171], a[144:147], v[96:99]
    v_fma_f32 v32, v32, v90, v86
    v_fma_f32 v33, v33, v90, v86
    v_mfma_f32_16x16x32_bf16 v[100:103], v[168:171], a[148:151], v[100:103]
    v_fma_f32 v34, v34, v90, v86
    v_mfma_f32_16x16x32_bf16 v[104:107], v[168:171], a[152:155], v[104:107]
    v_fma_f32 v35, v35, v90, v86
    v_mul_f32 v32, v120, v32
    v_mfma_f32_16x16x32_bf16 v[108:111], v[168:171], a[156:159], v[108:111]
    buffer_load_dwordx4 v[168:171], v21, s[12:15], s40 offen offset:2048
    v_mul_f32 v33, v121, v33
    v_mul_f32 v34, v122, v34
    v_mfma_f32_16x16x32_bf16 v[96:99], v[172:175], a[160:163], v[96:99]
    v_mul_f32 v35, v123, v35
    v_exp_f32 v32, v32
    v_mfma_f32_16x16x32_bf16 v[100:103], v[172:175], a[164:167], v[100:103]
    v_exp_f32 v33, v33
    v_mfma_f32_16x16x32_bf16 v[104:107], v[172:175], a[168:171], v[104:107]
    v_exp_f32 v34, v34
    v_exp_f32 v35, v35
    v_mfma_f32_16x16x32_bf16 v[108:111], v[172:175], a[172:175], v[108:111]
    buffer_load_dwordx4 v[172:175], v21, s[12:15], s40 offen offset:3072
    v_add_f32 v32, 1.0, v32
    v_add_f32 v33, 1.0, v33
    s_waitcnt vmcnt(15)
    v_mfma_f32_16x16x32_bf16 v[96:99], v[176:179], a[176:179], v[96:99]
    v_add_f32 v34, 1.0, v34
    v_mfma_f32_16x16x32_bf16 v[100:103], v[176:179], a[180:183], v[100:103]
    v_add_f32 v35, 1.0, v35
    v_rcp_f32 v32, v32
    v_mfma_f32_16x16x32_bf16 v[104:107], v[176:179], a[184:187], v[104:107]
    v_rcp_f32 v33, v33
    v_rcp_f32 v34, v34
    v_mfma_f32_16x16x32_bf16 v[108:111], v[176:179], a[188:191], v[108:111]
    buffer_load_dwordx4 v[176:179], v22, s[12:15], s40 offen offset:0
    v_rcp_f32 v35, v35
    v_mul_f32 v36, v120, v32
    v_mfma_f32_16x16x32_bf16 v[96:99], v[180:183], a[192:195], v[96:99]
    v_mul_f32 v37, v121, v33
    v_mfma_f32_16x16x32_bf16 v[100:103], v[180:183], a[196:199], v[100:103]
    v_mul_f32 v38, v122, v34
    v_mul_f32 v39, v123, v35
    v_mfma_f32_16x16x32_bf16 v[104:107], v[180:183], a[200:203], v[104:107]
    v_cvt_pk_bf16_f32 v52, v36, v37
    v_cvt_pk_bf16_f32 v53, v38, v39
    v_mfma_f32_16x16x32_bf16 v[108:111], v[180:183], a[204:207], v[108:111]
    buffer_load_dwordx4 v[180:183], v22, s[12:15], s40 offen offset:1024
    ds_write_b64 v17, v[52:53] offset:2048
    v_mfma_f32_16x16x32_bf16 v[96:99], v[184:187], a[208:211], v[96:99]
    v_mul_f32 v40, v124, v124
    v_mul_f32 v41, v125, v125
    v_mfma_f32_16x16x32_bf16 v[100:103], v[184:187], a[212:215], v[100:103]
    v_mul_f32 v42, v126, v126
    v_mul_f32 v43, v127, v127
    v_mfma_f32_16x16x32_bf16 v[104:107], v[184:187], a[216:219], v[104:107]
    v_fma_f32 v40, v40, v91, v87
    v_fma_f32 v41, v41, v91, v87
    v_mfma_f32_16x16x32_bf16 v[108:111], v[184:187], a[220:223], v[108:111]
    buffer_load_dwordx4 v[184:187], v22, s[12:15], s40 offen offset:2048
    v_fma_f32 v42, v42, v91, v87
    v_mfma_f32_16x16x32_bf16 v[96:99], v[188:191], a[224:227], v[96:99]
    v_fma_f32 v43, v43, v91, v87
    v_mul_f32 v40, v124, v40
    v_mfma_f32_16x16x32_bf16 v[100:103], v[188:191], a[228:231], v[100:103]
    v_mul_f32 v41, v125, v41
    v_mul_f32 v42, v126, v42
    v_mfma_f32_16x16x32_bf16 v[104:107], v[188:191], a[232:235], v[104:107]
    v_mul_f32 v43, v127, v43
    v_exp_f32 v40, v40
    v_mfma_f32_16x16x32_bf16 v[108:111], v[188:191], a[236:239], v[108:111]
    buffer_load_dwordx4 v[188:191], v22, s[12:15], s40 offen offset:3072
    v_exp_f32 v41, v41
    s_waitcnt vmcnt(16)
    v_mfma_f32_16x16x32_bf16 v[96:99], v[192:195], a[240:243], v[96:99]
    v_exp_f32 v42, v42
    v_exp_f32 v43, v43
    v_mfma_f32_16x16x32_bf16 v[100:103], v[192:195], a[244:247], v[100:103]
    v_add_f32 v40, 1.0, v40
    v_add_f32 v41, 1.0, v41
    v_mfma_f32_16x16x32_bf16 v[104:107], v[192:195], a[248:251], v[104:107]
    v_add_f32 v42, 1.0, v42
    v_mfma_f32_16x16x32_bf16 v[108:111], v[192:195], a[252:255], v[108:111]
    buffer_load_dwordx4 v[192:195], v23, s[12:15], s40 offen offset:0
    v_add_f32 v43, 1.0, v43
    v_rcp_f32 v40, v40
    v_mfma_f32_16x16x32_bf16 v[96:99], v[196:199], v[224:227], v[96:99]
    v_rcp_f32 v41, v41
    v_rcp_f32 v42, v42
    v_mfma_f32_16x16x32_bf16 v[100:103], v[196:199], v[228:231], v[100:103]
    v_rcp_f32 v43, v43
    v_mul_f32 v44, v124, v40
    v_mfma_f32_16x16x32_bf16 v[104:107], v[196:199], v[232:235], v[104:107]
    v_mul_f32 v45, v125, v41
    v_mfma_f32_16x16x32_bf16 v[108:111], v[196:199], v[236:239], v[108:111]
    buffer_load_dwordx4 v[196:199], v23, s[12:15], s40 offen offset:1024
    v_mul_f32 v46, v126, v42
    v_mul_f32 v47, v127, v43
    v_mfma_f32_16x16x32_bf16 v[96:99], v[200:203], v[240:243], v[96:99]
    v_cvt_pk_bf16_f32 v54, v44, v45
    v_cvt_pk_bf16_f32 v55, v46, v47
    v_mfma_f32_16x16x32_bf16 v[100:103], v[200:203], v[244:247], v[100:103]
    ds_write_b64 v17, v[54:55] offset:3072
    v_mfma_f32_16x16x32_bf16 v[104:107], v[200:203], v[248:251], v[104:107]
    v_mfma_f32_16x16x32_bf16 v[108:111], v[200:203], v[252:255], v[108:111]
    buffer_load_dwordx4 v[200:203], v23, s[12:15], s40 offen offset:2048
    v_add_u32 v19, 4096, v19
    v_add_u32 v17, 4096, v17
    s_cmp_lt_u32 s43, 9
    s_cbranch_scc1 k3_kernel_g1loop
    s_nop 2
    v_mul_f32 v32, v96, v96
    v_mul_f32 v33, v97, v97
    v_mul_f32 v34, v98, v98
    v_mul_f32 v35, v99, v99
    v_fma_f32 v32, v32, v88, v84
    v_fma_f32 v33, v33, v88, v84
    v_fma_f32 v34, v34, v88, v84
    v_fma_f32 v35, v35, v88, v84
    v_mul_f32 v32, v96, v32
    v_mul_f32 v33, v97, v33
    v_mul_f32 v34, v98, v34
    v_mul_f32 v35, v99, v35
    v_exp_f32 v32, v32
    v_exp_f32 v33, v33
    v_exp_f32 v34, v34
    v_exp_f32 v35, v35
    v_add_f32 v32, 1.0, v32
    v_add_f32 v33, 1.0, v33
    v_add_f32 v34, 1.0, v34
    v_add_f32 v35, 1.0, v35
    v_rcp_f32 v32, v32
    v_rcp_f32 v33, v33
    v_rcp_f32 v34, v34
    v_rcp_f32 v35, v35
    v_mul_f32 v36, v96, v32
    v_mul_f32 v37, v97, v33
    v_mul_f32 v38, v98, v34
    v_mul_f32 v39, v99, v35
    v_cvt_pk_bf16_f32 v48, v36, v37
    v_cvt_pk_bf16_f32 v49, v38, v39
    ds_write_b64 v19, v[48:49] offset:0
    v_mul_f32 v40, v100, v100
    v_mul_f32 v41, v101, v101
    v_mul_f32 v42, v102, v102
    v_mul_f32 v43, v103, v103
    v_fma_f32 v40, v40, v89, v85
    v_fma_f32 v41, v41, v89, v85
    v_fma_f32 v42, v42, v89, v85
    v_fma_f32 v43, v43, v89, v85
    v_mul_f32 v40, v100, v40
    v_mul_f32 v41, v101, v41
    v_mul_f32 v42, v102, v42
    v_mul_f32 v43, v103, v43
    v_exp_f32 v40, v40
    v_exp_f32 v41, v41
    v_exp_f32 v42, v42
    v_exp_f32 v43, v43
    v_add_f32 v40, 1.0, v40
    v_add_f32 v41, 1.0, v41
    v_add_f32 v42, 1.0, v42
    v_add_f32 v43, 1.0, v43
    v_rcp_f32 v40, v40
    v_rcp_f32 v41, v41
    v_rcp_f32 v42, v42
    v_rcp_f32 v43, v43
    v_mul_f32 v44, v100, v40
    v_mul_f32 v45, v101, v41
    v_mul_f32 v46, v102, v42
    v_mul_f32 v47, v103, v43
    v_cvt_pk_bf16_f32 v50, v44, v45
    v_cvt_pk_bf16_f32 v51, v46, v47
    ds_write_b64 v19, v[50:51] offset:1024
    v_mul_f32 v32, v104, v104
    v_mul_f32 v33, v105, v105
    v_mul_f32 v34, v106, v106
    v_mul_f32 v35, v107, v107
    v_fma_f32 v32, v32, v90, v86
    v_fma_f32 v33, v33, v90, v86
    v_fma_f32 v34, v34, v90, v86
    v_fma_f32 v35, v35, v90, v86
    v_mul_f32 v32, v104, v32
    v_mul_f32 v33, v105, v33
    v_mul_f32 v34, v106, v34
    v_mul_f32 v35, v107, v35
    v_exp_f32 v32, v32
    v_exp_f32 v33, v33
    v_exp_f32 v34, v34
    v_exp_f32 v35, v35
    v_add_f32 v32, 1.0, v32
    v_add_f32 v33, 1.0, v33
    v_add_f32 v34, 1.0, v34
    v_add_f32 v35, 1.0, v35
    v_rcp_f32 v32, v32
    v_rcp_f32 v33, v33
    v_rcp_f32 v34, v34
    v_rcp_f32 v35, v35
    v_mul_f32 v36, v104, v32
    v_mul_f32 v37, v105, v33
    v_mul_f32 v38, v106, v34
    v_mul_f32 v39, v107, v35
    v_cvt_pk_bf16_f32 v52, v36, v37
    v_cvt_pk_bf16_f32 v53, v38, v39
    ds_write_b64 v19, v[52:53] offset:2048
    v_mul_f32 v40, v108, v108
    v_mul_f32 v41, v109, v109
    v_mul_f32 v42, v110, v110
    v_mul_f32 v43, v111, v111
    v_fma_f32 v40, v40, v91, v87
    v_fma_f32 v41, v41, v91, v87
    v_fma_f32 v42, v42, v91, v87
    v_fma_f32 v43, v43, v91, v87
    v_mul_f32 v40, v108, v40
    v_mul_f32 v41, v109, v41
    v_mul_f32 v42, v110, v42
    v_mul_f32 v43, v111, v43
    v_exp_f32 v40, v40
    v_exp_f32 v41, v41
    v_exp_f32 v42, v42
    v_exp_f32 v43, v43
    v_add_f32 v40, 1.0, v40
    v_add_f32 v41, 1.0, v41
    v_add_f32 v42, 1.0, v42
    v_add_f32 v43, 1.0, v43
    v_rcp_f32 v40, v40
    v_rcp_f32 v41, v41
    v_rcp_f32 v42, v42
    v_rcp_f32 v43, v43
    v_mul_f32 v44, v108, v40
    v_mul_f32 v45, v109, v41
    v_mul_f32 v46, v110, v42
    v_mul_f32 v47, v111, v43
    v_cvt_pk_bf16_f32 v54, v44, v45
    v_cvt_pk_bf16_f32 v55, v46, v47
    ds_write_b64 v19, v[54:55] offset:3072
    s_mov_b32 s59, s36
    s_lshl_b32 s62, s29, 5
    s_add_u32 s62, s62, s30
    s_mul_i32 s62, s62, 36
    s_add_u32 s62, s62, s38
    s_lshl_b32 s62, s62, 11
    s_add_u32 s44, s41, 18432
    buffer_load_dwordx4 v[208:211], v2, s[12:15], s44 offen offset:1024
    buffer_load_dwordx4 v[212:215], v2, s[12:15], s44 offen offset:2048
    buffer_load_dwordx4 v[216:219], v2, s[12:15], s44 offen offset:3072
    buffer_load_dwordx4 v[220:223], v20, s[12:15], s44 offen offset:0
    buffer_load_dwordx4 v[40:43], v20, s[12:15], s44 offen offset:1024
    buffer_load_dwordx4 v[44:47], v20, s[12:15], s44 offen offset:2048
    buffer_load_dwordx4 v[48:51], v20, s[12:15], s44 offen offset:3072
    buffer_load_dwordx4 v[52:55], v21, s[12:15], s44 offen offset:0
    buffer_load_dwordx4 v[56:59], v21, s[12:15], s44 offen offset:1024
    buffer_load_dwordx4 v[60:63], v21, s[12:15], s44 offen offset:2048
    buffer_load_dwordx4 v[64:67], v21, s[12:15], s44 offen offset:3072
    buffer_load_dwordx4 v[68:71], v22, s[12:15], s44 offen offset:0
    buffer_load_dwordx4 v[72:75], v22, s[12:15], s44 offen offset:1024
    buffer_load_dwordx4 v[76:79], v22, s[12:15], s44 offen offset:2048
    buffer_load_dwordx4 v[80:83], v22, s[12:15], s44 offen offset:3072
    buffer_load_dwordx4 v[204:207], v23, s[12:15], s44 offen offset:0
    buffer_load_dwordx4 v[84:87], v23, s[12:15], s44 offen offset:1024
    s_waitcnt lgkmcnt(0)
    s_barrier
    s_mul_i32 s33, s28, 18
    s_mul_i32 s35, s29, 9
    s_sub_u32 s33, s33, s35
    s_mul_i32 s35, s28, 18432
    v_add_u32 v16, s35, v2
    s_add_u32 s44, s41, 36864
    s_mov_b32 s45, 0
    s_cmp_lt_u32 s45, 7
    s_cselect_b32 s40, s44, 0x70000000
    s_add_u32 s44, s44, 18432
    s_add_u32 s45, s45, 1
    ds_read_b128 a[0:3], v7 offset:0
    ds_read_b128 a[4:7], v7 offset:1024
    ds_read_b128 a[8:11], v7 offset:2048
    ds_read_b128 a[12:15], v7 offset:3072
    ds_read_b128 a[16:19], v7 offset:4096
    ds_read_b128 a[20:23], v7 offset:5120
    ds_read_b128 a[24:27], v7 offset:6144
    ds_read_b128 a[28:31], v7 offset:7168
    ds_read_b128 a[32:35], v7 offset:8192
    ds_read_b128 a[36:39], v7 offset:9216
    ds_read_b128 a[40:43], v7 offset:10240
    ds_read_b128 a[44:47], v7 offset:11264
    s_waitcnt vmcnt(32)
    ds_read_b128 a[48:51], v7 offset:12288
    ds_read_b128 a[52:55], v7 offset:13312
    ds_read_b128 a[56:59], v7 offset:14336
    ds_read_b128 a[60:63], v7 offset:15360
    s_waitcnt lgkmcnt(12)
    v_mfma_f32_16x16x32_bf16 v[96:99], v[128:131], a[0:3], 0
    v_mfma_f32_16x16x32_bf16 v[100:103], v[128:131], a[4:7], 0
    v_mfma_f32_16x16x32_bf16 v[104:107], v[128:131], a[8:11], 0
    v_mfma_f32_16x16x32_bf16 v[108:111], v[128:131], a[12:15], 0
    buffer_load_dwordx4 v[128:131], v2, s[12:15], s40 offen offset:0
    ds_read_b128 a[64:67], v7 offset:16384
    ds_read_b128 a[68:71], v7 offset:17408
    ds_read_b128 a[72:75], v7 offset:18432
    ds_read_b128 a[76:79], v7 offset:19456
    s_waitcnt lgkmcnt(12)
    v_mfma_f32_16x16x32_bf16 v[96:99], v[132:135], a[16:19], v[96:99]
    v_mfma_f32_16x16x32_bf16 v[100:103], v[132:135], a[20:23], v[100:103]
    v_mfma_f32_16x16x32_bf16 v[104:107], v[132:135], a[24:27], v[104:107]
    v_mfma_f32_16x16x32_bf16 v[108:111], v[132:135], a[28:31], v[108:111]
    buffer_load_dwordx4 v[132:135], v2, s[12:15], s40 offen offset:1024
    ds_read_b128 a[80:83], v7 offset:20480
    ds_read_b128 a[84:87], v7 offset:21504
    ds_read_b128 a[88:91], v7 offset:22528
    ds_read_b128 a[92:95], v7 offset:23552
    s_waitcnt lgkmcnt(12)
    v_mfma_f32_16x16x32_bf16 v[96:99], v[136:139], a[32:35], v[96:99]
    v_mfma_f32_16x16x32_bf16 v[100:103], v[136:139], a[36:39], v[100:103]
    v_mfma_f32_16x16x32_bf16 v[104:107], v[136:139], a[40:43], v[104:107]
    v_mfma_f32_16x16x32_bf16 v[108:111], v[136:139], a[44:47], v[108:111]
    buffer_load_dwordx4 v[136:139], v2, s[12:15], s40 offen offset:2048
    ds_read_b128 a[96:99], v7 offset:24576
    ds_read_b128 a[100:103], v7 offset:25600
    ds_read_b128 a[104:107], v7 offset:26624
    ds_read_b128 a[108:111], v7 offset:27648
    s_waitcnt lgkmcnt(12)
    v_mfma_f32_16x16x32_bf16 v[96:99], v[140:143], a[48:51], v[96:99]
    v_mfma_f32_16x16x32_bf16 v[100:103], v[140:143], a[52:55], v[100:103]
    v_mfma_f32_16x16x32_bf16 v[104:107], v[140:143], a[56:59], v[104:107]
    v_mfma_f32_16x16x32_bf16 v[108:111], v[140:143], a[60:63], v[108:111]
    buffer_load_dwordx4 v[140:143], v2, s[12:15], s40 offen offset:3072
    s_waitcnt vmcnt(32)
    ds_read_b128 a[112:115], v7 offset:28672
    ds_read_b128 a[116:119], v7 offset:29696
    ds_read_b128 a[120:123], v7 offset:30720
    ds_read_b128 a[124:127], v7 offset:31744
    s_waitcnt lgkmcnt(12)
    v_mfma_f32_16x16x32_bf16 v[96:99], v[144:147], a[64:67], v[96:99]
    v_mfma_f32_16x16x32_bf16 v[100:103], v[144:147], a[68:71], v[100:103]
    v_mfma_f32_16x16x32_bf16 v[104:107], v[144:147], a[72:75], v[104:107]
    v_mfma_f32_16x16x32_bf16 v[108:111], v[144:147], a[76:79], v[108:111]
    buffer_load_dwordx4 v[144:147], v20, s[12:15], s40 offen offset:0
    ds_read_b128 a[128:131], v18 offset:0
    ds_read_b128 a[132:135], v18 offset:1024
    ds_read_b128 a[136:139], v18 offset:2048
    ds_read_b128 a[140:143], v18 offset:3072
    s_waitcnt lgkmcnt(12)
    v_mfma_f32_16x16x32_bf16 v[96:99], v[148:151], a[80:83], v[96:99]
    v_mfma_f32_16x16x32_bf16 v[100:103], v[148:151], a[84:87], v[100:103]
    v_mfma_f32_16x16x32_bf16 v[104:107], v[148:151], a[88:91], v[104:107]
    v_mfma_f32_16x16x32_bf16 v[108:111], v[148:151], a[92:95], v[108:111]
    buffer_load_dwordx4 v[148:151], v20, s[12:15], s40 offen offset:1024
    ds_read_b128 a[144:147], v18 offset:4096
    ds_read_b128 a[148:151], v18 offset:5120
    ds_read_b128 a[152:155], v18 offset:6144
    ds_read_b128 a[156:159], v18 offset:7168
    s_waitcnt lgkmcnt(12)
    v_mfma_f32_16x16x32_bf16 v[96:99], v[152:155], a[96:99], v[96:99]
    v_mfma_f32_16x16x32_bf16 v[100:103], v[152:155], a[100:103], v[100:103]
    v_mfma_f32_16x16x32_bf16 v[104:107], v[152:155], a[104:107], v[104:107]
    v_mfma_f32_16x16x32_bf16 v[108:111], v[152:155], a[108:111], v[108:111]
    buffer_load_dwordx4 v[152:155], v20, s[12:15], s40 offen offset:2048
    ds_read_b128 a[160:163], v18 offset:8192
    ds_read_b128 a[164:167], v18 offset:9216
    ds_read_b128 a[168:171], v18 offset:10240
    ds_read_b128 a[172:175], v18 offset:11264
    s_waitcnt lgkmcnt(12)
    v_mfma_f32_16x16x32_bf16 v[96:99], v[156:159], a[112:115], v[96:99]
    v_mfma_f32_16x16x32_bf16 v[100:103], v[156:159], a[116:119], v[100:103]
    v_mfma_f32_16x16x32_bf16 v[104:107], v[156:159], a[120:123], v[104:107]
    v_mfma_f32_16x16x32_bf16 v[108:111], v[156:159], a[124:127], v[108:111]
    buffer_load_dwordx4 v[156:159], v20, s[12:15], s40 offen offset:3072
    s_waitcnt vmcnt(32)
    ds_read_b128 a[176:179], v18 offset:12288
    ds_read_b128 a[180:183], v18 offset:13312
    ds_read_b128 a[184:187], v18 offset:14336
    ds_read_b128 a[188:191], v18 offset:15360
    s_waitcnt lgkmcnt(12)
    v_mfma_f32_16x16x32_bf16 v[96:99], v[160:163], a[128:131], v[96:99]
    v_mfma_f32_16x16x32_bf16 v[100:103], v[160:163], a[132:135], v[100:103]
    v_mfma_f32_16x16x32_bf16 v[104:107], v[160:163], a[136:139], v[104:107]
    v_mfma_f32_16x16x32_bf16 v[108:111], v[160:163], a[140:143], v[108:111]
    buffer_load_dwordx4 v[160:163], v21, s[12:15], s40 offen offset:0
    ds_read_b128 a[192:195], v18 offset:16384
    ds_read_b128 a[196:199], v18 offset:17408
    ds_read_b128 a[200:203], v18 offset:18432
    ds_read_b128 a[204:207], v18 offset:19456
    s_waitcnt lgkmcnt(12)
    v_mfma_f32_16x16x32_bf16 v[96:99], v[164:167], a[144:147], v[96:99]
    v_mfma_f32_16x16x32_bf16 v[100:103], v[164:167], a[148:151], v[100:103]
    v_mfma_f32_16x16x32_bf16 v[104:107], v[164:167], a[152:155], v[104:107]
    v_mfma_f32_16x16x32_bf16 v[108:111], v[164:167], a[156:159], v[108:111]
    buffer_load_dwordx4 v[164:167], v21, s[12:15], s40 offen offset:1024
    ds_read_b128 a[208:211], v18 offset:20480
    ds_read_b128 a[212:215], v18 offset:21504
    ds_read_b128 a[216:219], v18 offset:22528
    ds_read_b128 a[220:223], v18 offset:23552
    s_waitcnt lgkmcnt(12)
    v_mfma_f32_16x16x32_bf16 v[96:99], v[168:171], a[160:163], v[96:99]
    v_mfma_f32_16x16x32_bf16 v[100:103], v[168:171], a[164:167], v[100:103]
    v_mfma_f32_16x16x32_bf16 v[104:107], v[168:171], a[168:171], v[104:107]
    v_mfma_f32_16x16x32_bf16 v[108:111], v[168:171], a[172:175], v[108:111]
    buffer_load_dwordx4 v[168:171], v21, s[12:15], s40 offen offset:2048
    ds_read_b128 a[224:227], v18 offset:24576
    ds_read_b128 a[228:231], v18 offset:25600
    ds_read_b128 a[232:235], v18 offset:26624
    ds_read_b128 a[236:239], v18 offset:27648
    s_waitcnt lgkmcnt(12)
    v_mfma_f32_16x16x32_bf16 v[96:99], v[172:175], a[176:179], v[96:99]
    v_mfma_f32_16x16x32_bf16 v[100:103], v[172:175], a[180:183], v[100:103]
    v_mfma_f32_16x16x32_bf16 v[104:107], v[172:175], a[184:187], v[104:107]
    v_mfma_f32_16x16x32_bf16 v[108:111], v[172:175], a[188:191], v[108:111]
    buffer_load_dwordx4 v[172:175], v21, s[12:15], s40 offen offset:3072
    s_waitcnt vmcnt(32)
    ds_read_b128 a[240:243], v18 offset:28672
    ds_read_b128 a[244:247], v18 offset:29696
    ds_read_b128 a[248:251], v18 offset:30720
    ds_read_b128 a[252:255], v18 offset:31744
    s_waitcnt lgkmcnt(12)
    v_mfma_f32_16x16x32_bf16 v[96:99], v[176:179], a[192:195], v[96:99]
    v_mfma_f32_16x16x32_bf16 v[100:103], v[176:179], a[196:199], v[100:103]
    v_mfma_f32_16x16x32_bf16 v[104:107], v[176:179], a[200:203], v[104:107]
    v_mfma_f32_16x16x32_bf16 v[108:111], v[176:179], a[204:207], v[108:111]
    buffer_load_dwordx4 v[176:179], v22, s[12:15], s40 offen offset:0
    ds_read_b128 v[224:227], v18 offset:32768
    ds_read_b128 v[228:231], v18 offset:33792
    ds_read_b128 v[232:235], v18 offset:34816
    ds_read_b128 v[236:239], v18 offset:35840
    s_waitcnt lgkmcnt(12)
    v_mfma_f32_16x16x32_bf16 v[96:99], v[180:183], a[208:211], v[96:99]
    v_mfma_f32_16x16x32_bf16 v[100:103], v[180:183], a[212:215], v[100:103]
    v_mfma_f32_16x16x32_bf16 v[104:107], v[180:183], a[216:219], v[104:107]
    v_mfma_f32_16x16x32_bf16 v[108:111], v[180:183], a[220:223], v[108:111]
    buffer_load_dwordx4 v[180:183], v22, s[12:15], s40 offen offset:1024
    ds_read_b128 v[240:243], v18 offset:36864
    ds_read_b128 v[244:247], v18 offset:37888
    ds_read_b128 v[248:251], v18 offset:38912
    ds_read_b128 v[252:255], v18 offset:39936
    s_waitcnt lgkmcnt(12)
    v_mfma_f32_16x16x32_bf16 v[96:99], v[184:187], a[224:227], v[96:99]
    v_mfma_f32_16x16x32_bf16 v[100:103], v[184:187], a[228:231], v[100:103]
    v_mfma_f32_16x16x32_bf16 v[104:107], v[184:187], a[232:235], v[104:107]
    v_mfma_f32_16x16x32_bf16 v[108:111], v[184:187], a[236:239], v[108:111]
    buffer_load_dwordx4 v[184:187], v22, s[12:15], s40 offen offset:2048
    s_waitcnt lgkmcnt(8)
    v_mfma_f32_16x16x32_bf16 v[96:99], v[188:191], a[240:243], v[96:99]
    v_mfma_f32_16x16x32_bf16 v[100:103], v[188:191], a[244:247], v[100:103]
    v_mfma_f32_16x16x32_bf16 v[104:107], v[188:191], a[248:251], v[104:107]
    v_mfma_f32_16x16x32_bf16 v[108:111], v[188:191], a[252:255], v[108:111]
    buffer_load_dwordx4 v[188:191], v22, s[12:15], s40 offen offset:3072
    s_waitcnt vmcnt(34)
    s_waitcnt lgkmcnt(4)
    v_mfma_f32_16x16x32_bf16 v[96:99], v[192:195], v[224:227], v[96:99]
    v_mfma_f32_16x16x32_bf16 v[100:103], v[192:195], v[228:231], v[100:103]
    v_mfma_f32_16x16x32_bf16 v[104:107], v[192:195], v[232:235], v[104:107]
    v_mfma_f32_16x16x32_bf16 v[108:111], v[192:195], v[236:239], v[108:111]
    buffer_load_dwordx4 v[192:195], v23, s[12:15], s40 offen offset:0
    s_waitcnt lgkmcnt(0)
    v_mfma_f32_16x16x32_bf16 v[96:99], v[196:199], v[240:243], v[96:99]
    v_mfma_f32_16x16x32_bf16 v[100:103], v[196:199], v[244:247], v[100:103]
    v_mfma_f32_16x16x32_bf16 v[104:107], v[196:199], v[248:251], v[104:107]
    v_mfma_f32_16x16x32_bf16 v[108:111], v[196:199], v[252:255], v[108:111]
    buffer_load_dwordx4 v[196:199], v23, s[12:15], s40 offen offset:1024
k3_kernel_g2loop:
    s_cmp_lt_u32 s45, 7
    s_cselect_b32 s40, s44, 0x70000000
    s_add_u32 s44, s44, 18432
    s_add_u32 s45, s45, 1
    s_waitcnt vmcnt(32)
    v_mfma_f32_16x16x32_bf16 v[112:115], v[200:203], a[0:3], 0
    v_mfma_f32_16x16x32_bf16 v[116:119], v[200:203], a[4:7], 0
    v_mfma_f32_16x16x32_bf16 v[120:123], v[200:203], a[8:11], 0
    v_mul_f32 v96, v92, v96
    v_mfma_f32_16x16x32_bf16 v[124:127], v[200:203], a[12:15], 0
    buffer_load_dwordx4 v[200:203], v2, s[12:15], s40 offen offset:0
    v_mul_f32 v97, v92, v97
    v_mfma_f32_16x16x32_bf16 v[112:115], v[208:211], a[16:19], v[112:115]
    v_mul_f32 v98, v92, v98
    v_mfma_f32_16x16x32_bf16 v[116:119], v[208:211], a[20:23], v[116:119]
    v_mul_f32 v99, v92, v99
    v_mfma_f32_16x16x32_bf16 v[120:123], v[208:211], a[24:27], v[120:123]
    v_cvt_pk_bf16_f32 v32, v96, v97
    v_mfma_f32_16x16x32_bf16 v[124:127], v[208:211], a[28:31], v[124:127]
    buffer_load_dwordx4 v[208:211], v2, s[12:15], s40 offen offset:1024
    v_cvt_pk_bf16_f32 v33, v98, v99
    v_mfma_f32_16x16x32_bf16 v[112:115], v[212:215], a[32:35], v[112:115]
    v_mul_f32 v100, v93, v100
    v_mfma_f32_16x16x32_bf16 v[116:119], v[212:215], a[36:39], v[116:119]
    v_mul_f32 v101, v93, v101
    v_mfma_f32_16x16x32_bf16 v[120:123], v[212:215], a[40:43], v[120:123]
    v_mul_f32 v102, v93, v102
    v_mfma_f32_16x16x32_bf16 v[124:127], v[212:215], a[44:47], v[124:127]
    buffer_load_dwordx4 v[212:215], v2, s[12:15], s40 offen offset:2048
    v_mul_f32 v103, v93, v103
    v_mfma_f32_16x16x32_bf16 v[112:115], v[216:219], a[48:51], v[112:115]
    v_cvt_pk_bf16_f32 v34, v100, v101
    v_mfma_f32_16x16x32_bf16 v[116:119], v[216:219], a[52:55], v[116:119]
    v_cvt_pk_bf16_f32 v35, v102, v103
    v_mfma_f32_16x16x32_bf16 v[120:123], v[216:219], a[56:59], v[120:123]
    s_add_u32 s35, s33, 0
    v_mfma_f32_16x16x32_bf16 v[124:127], v[216:219], a[60:63], v[124:127]
    buffer_load_dwordx4 v[216:219], v2, s[12:15], s40 offen offset:3072
    s_cmp_lt_u32 s35, 9
    s_waitcnt vmcnt(32)
    v_mfma_f32_16x16x32_bf16 v[112:115], v[220:223], a[64:67], v[112:115]
    s_cselect_b32 s39, 0x40000000, s62
    v_mfma_f32_16x16x32_bf16 v[116:119], v[220:223], a[68:71], v[116:119]
    ds_write_b128 v16, v[32:35] offset:0
    v_mfma_f32_16x16x32_bf16 v[120:123], v[220:223], a[72:75], v[120:123]
    buffer_store_dwordx4 v[32:35], v2, s[20:23], s39 offen offset:0 sc1
    v_mfma_f32_16x16x32_bf16 v[124:127], v[220:223], a[76:79], v[124:127]
    buffer_load_dwordx4 v[220:223], v20, s[12:15], s40 offen offset:0
    v_mul_f32 v104, v94, v104
    v_mfma_f32_16x16x32_bf16 v[112:115], v[40:43], a[80:83], v[112:115]
    v_mul_f32 v105, v94, v105
    v_mfma_f32_16x16x32_bf16 v[116:119], v[40:43], a[84:87], v[116:119]
    v_mul_f32 v106, v94, v106
    v_mfma_f32_16x16x32_bf16 v[120:123], v[40:43], a[88:91], v[120:123]
    v_mul_f32 v107, v94, v107
    v_mfma_f32_16x16x32_bf16 v[124:127], v[40:43], a[92:95], v[124:127]
    buffer_load_dwordx4 v[40:43], v20, s[12:15], s40 offen offset:1024
    v_cvt_pk_bf16_f32 v36, v104, v105
    v_mfma_f32_16x16x32_bf16 v[112:115], v[44:47], a[96:99], v[112:115]
    v_cvt_pk_bf16_f32 v37, v106, v107
    v_mfma_f32_16x16x32_bf16 v[116:119], v[44:47], a[100:103], v[116:119]
    v_mul_f32 v108, v95, v108
    v_mfma_f32_16x16x32_bf16 v[120:123], v[44:47], a[104:107], v[120:123]
    v_mul_f32 v109, v95, v109
    v_mfma_f32_16x16x32_bf16 v[124:127], v[44:47], a[108:111], v[124:127]
    buffer_load_dwordx4 v[44:47], v20, s[12:15], s40 offen offset:2048
    v_mul_f32 v110, v95, v110
    v_mfma_f32_16x16x32_bf16 v[112:115], v[48:51], a[112:115], v[112:115]
    v_mul_f32 v111, v95, v111
    v_mfma_f32_16x16x32_bf16 v[116:119], v[48:51], a[116:119], v[116:119]
    v_cvt_pk_bf16_f32 v38, v108, v109
    v_mfma_f32_16x16x32_bf16 v[120:123], v[48:51], a[120:123], v[120:123]
    v_cvt_pk_bf16_f32 v39, v110, v111
    v_mfma_f32_16x16x32_bf16 v[124:127], v[48:51], a[124:127], v[124:127]
    buffer_load_dwordx4 v[48:51], v20, s[12:15], s40 offen offset:3072
    s_add_u32 s35, s33, 1
    s_waitcnt vmcnt(32)
    v_mfma_f32_16x16x32_bf16 v[112:115], v[52:55], a[128:131], v[112:115]
    s_cmp_lt_u32 s35, 9
    v_mfma_f32_16x16x32_bf16 v[116:119], v[52:55], a[132:135], v[116:119]
    s_cselect_b32 s39, 0x40000000, s62
    v_mfma_f32_16x16x32_bf16 v[120:123], v[52:55], a[136:139], v[120:123]
    ds_write_b128 v16, v[36:39] offset:1024
    v_mfma_f32_16x16x32_bf16 v[124:127], v[52:55], a[140:143], v[124:127]
    buffer_load_dwordx4 v[52:55], v21, s[12:15], s40 offen offset:0
    buffer_store_dwordx4 v[36:39], v2, s[20:23], s39 offen offset:1024 sc1
    v_mfma_f32_16x16x32_bf16 v[112:115], v[56:59], a[144:147], v[112:115]
    s_add_u32 s33, s33, 2
    v_mfma_f32_16x16x32_bf16 v[116:119], v[56:59], a[148:151], v[116:119]
    s_add_u32 s62, s62, 2048
    v_mfma_f32_16x16x32_bf16 v[120:123], v[56:59], a[152:155], v[120:123]
    v_add_u32 v16, 2048, v16
    v_mfma_f32_16x16x32_bf16 v[124:127], v[56:59], a[156:159], v[124:127]
    buffer_load_dwordx4 v[56:59], v21, s[12:15], s40 offen offset:1024
    v_mfma_f32_16x16x32_bf16 v[112:115], v[60:63], a[160:163], v[112:115]
    v_mfma_f32_16x16x32_bf16 v[116:119], v[60:63], a[164:167], v[116:119]
    v_mfma_f32_16x16x32_bf16 v[120:123], v[60:63], a[168:171], v[120:123]
    v_mfma_f32_16x16x32_bf16 v[124:127], v[60:63], a[172:175], v[124:127]
    buffer_load_dwordx4 v[60:63], v21, s[12:15], s40 offen offset:2048
    v_mfma_f32_16x16x32_bf16 v[112:115], v[64:67], a[176:179], v[112:115]
    v_mfma_f32_16x16x32_bf16 v[116:119], v[64:67], a[180:183], v[116:119]
    v_mfma_f32_16x16x32_bf16 v[120:123], v[64:67], a[184:187], v[120:123]
    v_mfma_f32_16x16x32_bf16 v[124:127], v[64:67], a[188:191], v[124:127]
    buffer_load_dwordx4 v[64:67], v21, s[12:15], s40 offen offset:3072
    s_waitcnt vmcnt(32)
    v_mfma_f32_16x16x32_bf16 v[112:115], v[68:71], a[192:195], v[112:115]
    v_mfma_f32_16x16x32_bf16 v[116:119], v[68:71], a[196:199], v[116:119]
    v_mfma_f32_16x16x32_bf16 v[120:123], v[68:71], a[200:203], v[120:123]
    v_mfma_f32_16x16x32_bf16 v[124:127], v[68:71], a[204:207], v[124:127]
    buffer_load_dwordx4 v[68:71], v22, s[12:15], s40 offen offset:0
    v_mfma_f32_16x16x32_bf16 v[112:115], v[72:75], a[208:211], v[112:115]
    v_mfma_f32_16x16x32_bf16 v[116:119], v[72:75], a[212:215], v[116:119]
    v_mfma_f32_16x16x32_bf16 v[120:123], v[72:75], a[216:219], v[120:123]
    v_mfma_f32_16x16x32_bf16 v[124:127], v[72:75], a[220:223], v[124:127]
    buffer_load_dwordx4 v[72:75], v22, s[12:15], s40 offen offset:1024
    v_mfma_f32_16x16x32_bf16 v[112:115], v[76:79], a[224:227], v[112:115]
    v_mfma_f32_16x16x32_bf16 v[116:119], v[76:79], a[228:231], v[116:119]
    v_mfma_f32_16x16x32_bf16 v[120:123], v[76:79], a[232:235], v[120:123]
    v_mfma_f32_16x16x32_bf16 v[124:127], v[76:79], a[236:239], v[124:127]
    buffer_load_dwordx4 v[76:79], v22, s[12:15], s40 offen offset:2048
    v_mfma_f32_16x16x32_bf16 v[112:115], v[80:83], a[240:243], v[112:115]
    v_mfma_f32_16x16x32_bf16 v[116:119], v[80:83], a[244:247], v[116:119]
    v_mfma_f32_16x16x32_bf16 v[120:123], v[80:83], a[248:251], v[120:123]
    v_mfma_f32_16x16x32_bf16 v[124:127], v[80:83], a[252:255], v[124:127]
    buffer_load_dwordx4 v[80:83], v22, s[12:15], s40 offen offset:3072
    s_waitcnt vmcnt(34)
    v_mfma_f32_16x16x32_bf16 v[112:115], v[204:207], v[224:227], v[112:115]
    v_mfma_f32_16x16x32_bf16 v[116:119], v[204:207], v[228:231], v[116:119]
    v_mfma_f32_16x16x32_bf16 v[120:123], v[204:207], v[232:235], v[120:123]
    v_mfma_f32_16x16x32_bf16 v[124:127], v[204:207], v[236:239], v[124:127]
    buffer_load_dwordx4 v[204:207], v23, s[12:15], s40 offen offset:0
    v_mfma_f32_16x16x32_bf16 v[112:115], v[84:87], v[240:243], v[112:115]
    v_mfma_f32_16x16x32_bf16 v[116:119], v[84:87], v[244:247], v[116:119]
    v_mfma_f32_16x16x32_bf16 v[120:123], v[84:87], v[248:251], v[120:123]
    v_mfma_f32_16x16x32_bf16 v[124:127], v[84:87], v[252:255], v[124:127]
    buffer_load_dwordx4 v[84:87], v23, s[12:15], s40 offen offset:1024
    s_cmp_lt_u32 s45, 7
    s_cselect_b32 s40, s44, 0x70000000
    s_add_u32 s44, s44, 18432
    s_add_u32 s45, s45, 1
    s_waitcnt vmcnt(32)
    v_mfma_f32_16x16x32_bf16 v[96:99], v[128:131], a[0:3], 0
    v_mfma_f32_16x16x32_bf16 v[100:103], v[128:131], a[4:7], 0
    v_mfma_f32_16x16x32_bf16 v[104:107], v[128:131], a[8:11], 0
    v_mul_f32 v112, v92, v112
    v_mfma_f32_16x16x32_bf16 v[108:111], v[128:131], a[12:15], 0
    buffer_load_dwordx4 v[128:131], v2, s[12:15], s40 offen offset:0
    v_mul_f32 v113, v92, v113
    v_mfma_f32_16x16x32_bf16 v[96:99], v[132:135], a[16:19], v[96:99]
    v_mul_f32 v114, v92, v114
    v_mfma_f32_16x16x32_bf16 v[100:103], v[132:135], a[20:23], v[100:103]
    v_mul_f32 v115, v92, v115
    v_mfma_f32_16x16x32_bf16 v[104:107], v[132:135], a[24:27], v[104:107]
    v_cvt_pk_bf16_f32 v32, v112, v113
    v_mfma_f32_16x16x32_bf16 v[108:111], v[132:135], a[28:31], v[108:111]
    buffer_load_dwordx4 v[132:135], v2, s[12:15], s40 offen offset:1024
    v_cvt_pk_bf16_f32 v33, v114, v115
    v_mfma_f32_16x16x32_bf16 v[96:99], v[136:139], a[32:35], v[96:99]
    v_mul_f32 v116, v93, v116
    v_mfma_f32_16x16x32_bf16 v[100:103], v[136:139], a[36:39], v[100:103]
    v_mul_f32 v117, v93, v117
    v_mfma_f32_16x16x32_bf16 v[104:107], v[136:139], a[40:43], v[104:107]
    v_mul_f32 v118, v93, v118
    v_mfma_f32_16x16x32_bf16 v[108:111], v[136:139], a[44:47], v[108:111]
    buffer_load_dwordx4 v[136:139], v2, s[12:15], s40 offen offset:2048
    v_mul_f32 v119, v93, v119
    v_mfma_f32_16x16x32_bf16 v[96:99], v[140:143], a[48:51], v[96:99]
    v_cvt_pk_bf16_f32 v34, v116, v117
    v_mfma_f32_16x16x32_bf16 v[100:103], v[140:143], a[52:55], v[100:103]
    v_cvt_pk_bf16_f32 v35, v118, v119
    v_mfma_f32_16x16x32_bf16 v[104:107], v[140:143], a[56:59], v[104:107]
    s_add_u32 s35, s33, 0
    v_mfma_f32_16x16x32_bf16 v[108:111], v[140:143], a[60:63], v[108:111]
    buffer_load_dwordx4 v[140:143], v2, s[12:15], s40 offen offset:3072
    s_cmp_lt_u32 s35, 9
    s_waitcnt vmcnt(32)
    v_mfma_f32_16x16x32_bf16 v[96:99], v[144:147], a[64:67], v[96:99]
    s_cselect_b32 s39, 0x40000000, s62
    v_mfma_f32_16x16x32_bf16 v[100:103], v[144:147], a[68:71], v[100:103]
    ds_write_b128 v16, v[32:35] offset:0
    v_mfma_f32_16x16x32_bf16 v[104:107], v[144:147], a[72:75], v[104:107]
    buffer_store_dwordx4 v[32:35], v2, s[20:23], s39 offen offset:0 sc1
    v_mfma_f32_16x16x32_bf16 v[108:111], v[144:147], a[76:79], v[108:111]
    buffer_load_dwordx4 v[144:147], v20, s[12:15], s40 offen offset:0
    v_mul_f32 v120, v94, v120
    v_mfma_f32_16x16x32_bf16 v[96:99], v[148:151], a[80:83], v[96:99]
    v_mul_f32 v121, v94, v121
    v_mfma_f32_16x16x32_bf16 v[100:103], v[148:151], a[84:87], v[100:103]
    v_mul_f32 v122, v94, v122
    v_mfma_f32_16x16x32_bf16 v[104:107], v[148:151], a[88:91], v[104:107]
    v_mul_f32 v123, v94, v123
    v_mfma_f32_16x16x32_bf16 v[108:111], v[148:151], a[92:95], v[108:111]
    buffer_load_dwordx4 v[148:151], v20, s[12:15], s40 offen offset:1024
    v_cvt_pk_bf16_f32 v36, v120, v121
    v_mfma_f32_16x16x32_bf16 v[96:99], v[152:155], a[96:99], v[96:99]
    v_cvt_pk_bf16_f32 v37, v122, v123
    v_mfma_f32_16x16x32_bf16 v[100:103], v[152:155], a[100:103], v[100:103]
    v_mul_f32 v124, v95, v124
    v_mfma_f32_16x16x32_bf16 v[104:107], v[152:155], a[104:107], v[104:107]
    v_mul_f32 v125, v95, v125
    v_mfma_f32_16x16x32_bf16 v[108:111], v[152:155], a[108:111], v[108:111]
    buffer_load_dwordx4 v[152:155], v20, s[12:15], s40 offen offset:2048
    v_mul_f32 v126, v95, v126
    v_mfma_f32_16x16x32_bf16 v[96:99], v[156:159], a[112:115], v[96:99]
    v_mul_f32 v127, v95, v127
    v_mfma_f32_16x16x32_bf16 v[100:103], v[156:159], a[116:119], v[100:103]
    v_cvt_pk_bf16_f32 v38, v124, v125
    v_mfma_f32_16x16x32_bf16 v[104:107], v[156:159], a[120:123], v[104:107]
    v_cvt_pk_bf16_f32 v39, v126, v127
    v_mfma_f32_16x16x32_bf16 v[108:111], v[156:159], a[124:127], v[108:111]
    buffer_load_dwordx4 v[156:159], v20, s[12:15], s40 offen offset:3072
    s_add_u32 s35, s33, 1
    s_waitcnt vmcnt(32)
    v_mfma_f32_16x16x32_bf16 v[96:99], v[160:163], a[128:131], v[96:99]
    s_cmp_lt_u32 s35, 9
    v_mfma_f32_16x16x32_bf16 v[100:103], v[160:163], a[132:135], v[100:103]
    s_cselect_b32 s39, 0x40000000, s62
    v_mfma_f32_16x16x32_bf16 v[104:107], v[160:163], a[136:139], v[104:107]
    ds_write_b128 v16, v[36:39] offset:1024
    v_mfma_f32_16x16x32_bf16 v[108:111], v[160:163], a[140:143], v[108:111]
    buffer_load_dwordx4 v[160:163], v21, s[12:15], s40 offen offset:0
    buffer_store_dwordx4 v[36:39], v2, s[20:23], s39 offen offset:1024 sc1
    v_mfma_f32_16x16x32_bf16 v[96:99], v[164:167], a[144:147], v[96:99]
    s_add_u32 s33, s33, 2
    v_mfma_f32_16x16x32_bf16 v[100:103], v[164:167], a[148:151], v[100:103]
    s_add_u32 s62, s62, 2048
    v_mfma_f32_16x16x32_bf16 v[104:107], v[164:167], a[152:155], v[104:107]
    v_add_u32 v16, 2048, v16
    v_mfma_f32_16x16x32_bf16 v[108:111], v[164:167], a[156:159], v[108:111]
    buffer_load_dwordx4 v[164:167], v21, s[12:15], s40 offen offset:1024
    v_mfma_f32_16x16x32_bf16 v[96:99], v[168:171], a[160:163], v[96:99]
    v_mfma_f32_16x16x32_bf16 v[100:103], v[168:171], a[164:167], v[100:103]
    v_mfma_f32_16x16x32_bf16 v[104:107], v[168:171], a[168:171], v[104:107]
    v_mfma_f32_16x16x32_bf16 v[108:111], v[168:171], a[172:175], v[108:111]
    buffer_load_dwordx4 v[168:171], v21, s[12:15], s40 offen offset:2048
    v_mfma_f32_16x16x32_bf16 v[96:99], v[172:175], a[176:179], v[96:99]
    v_mfma_f32_16x16x32_bf16 v[100:103], v[172:175], a[180:183], v[100:103]
    v_mfma_f32_16x16x32_bf16 v[104:107], v[172:175], a[184:187], v[104:107]
    v_mfma_f32_16x16x32_bf16 v[108:111], v[172:175], a[188:191], v[108:111]
    buffer_load_dwordx4 v[172:175], v21, s[12:15], s40 offen offset:3072
    s_waitcnt vmcnt(32)
    v_mfma_f32_16x16x32_bf16 v[96:99], v[176:179], a[192:195], v[96:99]
    v_mfma_f32_16x16x32_bf16 v[100:103], v[176:179], a[196:199], v[100:103]
    v_mfma_f32_16x16x32_bf16 v[104:107], v[176:179], a[200:203], v[104:107]
    v_mfma_f32_16x16x32_bf16 v[108:111], v[176:179], a[204:207], v[108:111]
    buffer_load_dwordx4 v[176:179], v22, s[12:15], s40 offen offset:0
    v_mfma_f32_16x16x32_bf16 v[96:99], v[180:183], a[208:211], v[96:99]
    v_mfma_f32_16x16x32_bf16 v[100:103], v[180:183], a[212:215], v[100:103]
    v_mfma_f32_16x16x32_bf16 v[104:107], v[180:183], a[216:219], v[104:107]
    v_mfma_f32_16x16x32_bf16 v[108:111], v[180:183], a[220:223], v[108:111]
    buffer_load_dwordx4 v[180:183], v22, s[12:15], s40 offen offset:1024
    v_mfma_f32_16x16x32_bf16 v[96:99], v[184:187], a[224:227], v[96:99]
    v_mfma_f32_16x16x32_bf16 v[100:103], v[184:187], a[228:231], v[100:103]
    v_mfma_f32_16x16x32_bf16 v[104:107], v[184:187], a[232:235], v[104:107]
    v_mfma_f32_16x16x32_bf16 v[108:111], v[184:187], a[236:239], v[108:111]
    buffer_load_dwordx4 v[184:187], v22, s[12:15], s40 offen offset:2048
    v_mfma_f32_16x16x32_bf16 v[96:99], v[188:191], a[240:243], v[96:99]
    v_mfma_f32_16x16x32_bf16 v[100:103], v[188:191], a[244:247], v[100:103]
    v_mfma_f32_16x16x32_bf16 v[104:107], v[188:191], a[248:251], v[104:107]
    v_mfma_f32_16x16x32_bf16 v[108:111], v[188:191], a[252:255], v[108:111]
    buffer_load_dwordx4 v[188:191], v22, s[12:15], s40 offen offset:3072
    s_waitcnt vmcnt(34)
    v_mfma_f32_16x16x32_bf16 v[96:99], v[192:195], v[224:227], v[96:99]
    v_mfma_f32_16x16x32_bf16 v[100:103], v[192:195], v[228:231], v[100:103]
    v_mfma_f32_16x16x32_bf16 v[104:107], v[192:195], v[232:235], v[104:107]
    v_mfma_f32_16x16x32_bf16 v[108:111], v[192:195], v[236:239], v[108:111]
    buffer_load_dwordx4 v[192:195], v23, s[12:15], s40 offen offset:0
    v_mfma_f32_16x16x32_bf16 v[96:99], v[196:199], v[240:243], v[96:99]
    v_mfma_f32_16x16x32_bf16 v[100:103], v[196:199], v[244:247], v[100:103]
    v_mfma_f32_16x16x32_bf16 v[104:107], v[196:199], v[248:251], v[104:107]
    v_mfma_f32_16x16x32_bf16 v[108:111], v[196:199], v[252:255], v[108:111]
    buffer_load_dwordx4 v[196:199], v23, s[12:15], s40 offen offset:1024
    s_cmp_lt_u32 s45, 9
    s_cbranch_scc1 k3_kernel_g2loop
    s_nop 6
    v_mul_f32 v96, v92, v96
    v_mul_f32 v97, v92, v97
    v_mul_f32 v98, v92, v98
    v_mul_f32 v99, v92, v99
    v_cvt_pk_bf16_f32 v32, v96, v97
    v_cvt_pk_bf16_f32 v33, v98, v99
    v_mul_f32 v100, v93, v100
    v_mul_f32 v101, v93, v101
    v_mul_f32 v102, v93, v102
    v_mul_f32 v103, v93, v103
    v_cvt_pk_bf16_f32 v34, v100, v101
    v_cvt_pk_bf16_f32 v35, v102, v103
    s_add_u32 s35, s33, 0
    s_cmp_lt_u32 s35, 9
    s_cselect_b32 s39, 0x40000000, s62
    ds_write_b128 v16, v[32:35] offset:0
    buffer_store_dwordx4 v[32:35], v2, s[20:23], s39 offen offset:0 sc1
    v_mul_f32 v104, v94, v104
    v_mul_f32 v105, v94, v105
    v_mul_f32 v106, v94, v106
    v_mul_f32 v107, v94, v107
    v_cvt_pk_bf16_f32 v36, v104, v105
    v_cvt_pk_bf16_f32 v37, v106, v107
    v_mul_f32 v108, v95, v108
    v_mul_f32 v109, v95, v109
    v_mul_f32 v110, v95, v110
    v_mul_f32 v111, v95, v111
    v_cvt_pk_bf16_f32 v38, v108, v109
    v_cvt_pk_bf16_f32 v39, v110, v111
    s_add_u32 s35, s33, 1
    s_cmp_lt_u32 s35, 9
    s_cselect_b32 s39, 0x40000000, s62
    ds_write_b128 v16, v[36:39] offset:1024
    buffer_store_dwordx4 v[36:39], v2, s[20:23], s39 offen offset:1024 sc1
    s_add_u32 s33, s33, 2
    s_add_u32 s62, s62, 2048
    v_add_u32 v16, 2048, v16
    s_add_u32 s8, s4, 0xdb7a000
    s_addc_u32 s9, s5, 0
    s_mov_b32 s10, 0x240000
    s_mov_b32 s11, 0x00020000
    s_add_u32 s12, s4, 0xde4b000
    s_addc_u32 s13, s5, 0
    s_mov_b32 s14, 0x2000
    s_mov_b32 s15, 0x00020000
    s_mov_b32 s16, s24
    s_mov_b32 s17, s25
    s_mov_b32 s18, 0x480
    s_mov_b32 s19, 0x00020000
    s_mul_i32 s40, s29, 9
    s_add_u32 s40, s40, s28
    v_lshrrev_b32 v3, 4, v1
    v_lshlrev_b32 v3, 3, v3
    v_and_b32 v4, 15, v1
    s_add_u32 s41, s40, 0
    s_lshr_b32 s42, s41, 1
    s_and_b32 s43, s41, 1
    s_lshl_b32 s44, s30, 2
    s_lshl_b32 s45, s43, 1
    s_add_u32 s44, s44, s45
    s_mul_i32 s46, s44, 18
    s_lshr_b32 s47, s42, 1
    s_add_u32 s46, s46, s47
    s_lshl_b32 s46, s46, 10
    s_and_b32 s47, s42, 1
    s_lshl_b32 s47, s47, 3
    s_add_u32 s46, s46, s47
    buffer_load_dwordx2 v[128:129], v2, s[8:11], s46 offen
    s_add_u32 s46, s46, 18432
    buffer_load_dwordx2 v[130:131], v2, s[8:11], s46 offen
    s_lshl_b32 s47, s42, 5
    buffer_load_dwordx2 v[132:133], v3, s[16:19], s47 offen
    s_add_u32 s41, s40, 4
    s_lshr_b32 s42, s41, 1
    s_and_b32 s43, s41, 1
    s_lshl_b32 s44, s30, 2
    s_lshl_b32 s45, s43, 1
    s_add_u32 s44, s44, s45
    s_mul_i32 s46, s44, 18
    s_lshr_b32 s47, s42, 1
    s_add_u32 s46, s46, s47
    s_lshl_b32 s46, s46, 10
    s_and_b32 s47, s42, 1
    s_lshl_b32 s47, s47, 3
    s_add_u32 s46, s46, s47
    buffer_load_dwordx2 v[136:137], v2, s[8:11], s46 offen
    s_add_u32 s46, s46, 18432
    buffer_load_dwordx2 v[138:139], v2, s[8:11], s46 offen
    s_lshl_b32 s47, s42, 5
    buffer_load_dwordx2 v[140:141], v3, s[16:19], s47 offen
    s_cmp_lg_u32 s28, 0
    s_cbranch_scc1 k3_kernel_nou2a
    s_add_u32 s41, s40, 8
    s_lshr_b32 s42, s41, 1
    s_and_b32 s43, s41, 1
    s_lshl_b32 s44, s30, 2
    s_lshl_b32 s45, s43, 1
    s_add_u32 s44, s44, s45
    s_mul_i32 s46, s44, 18
    s_lshr_b32 s47, s42, 1
    s_add_u32 s46, s46, s47
    s_lshl_b32 s46, s46, 10
    s_and_b32 s47, s42, 1
    s_lshl_b32 s47, s47, 3
    s_add_u32 s46, s46, s47
    buffer_load_dwordx2 v[144:145], v2, s[8:11], s46 offen
    s_add_u32 s46, s46, 18432
    buffer_load_dwordx2 v[146:147], v2, s[8:11], s46 offen
    s_lshl_b32 s47, s42, 5
    buffer_load_dwordx2 v[148:149], v3, s[16:19], s47 offen
k3_kernel_nou2a:
    s_waitcnt vmcnt(0) lgkmcnt(0)
    s_barrier
    s_lshl_b32 s48, s30, 7
    s_cmp_lg_u32 s28, 0
    s_cbranch_scc1 k3_kernel_noflag
    s_lshl_b32 s49, s29, 2
    s_add_u32 s49, s49, s48
    v_mov_b32 v5, 1
    v_mov_b32 v6, 0
    s_mov_b64 exec, 1
    buffer_store_dword v5, v6, s[12:15], s49 offen sc1
    s_mov_b64 exec, -1
k3_kernel_noflag:
    s_cmp_lg_u32 s28, 0
    s_cbranch_scc1 k3_kernel_fgot
    v_lshlrev_b32 v5, 2, v1
    s_mov_b32 s50, 20000
    s_mov_b64 exec, 0xff
k3_kernel_fpoll:
    buffer_load_dword v6, v5, s[12:15], s48 offen sc1
    s_waitcnt vmcnt(0)
    v_cmp_ne_u32 vcc, 1, v6
    s_cbranch_vccz k3_kernel_fgot1
    s_sub_u32 s50, s50, 1
    s_cmp_eq_u32 s50, 0
    s_cbranch_scc1 k3_kernel_fgot1
    s_sleep 4
    s_branch k3_kernel_fpoll
k3_kernel_fgot1:
    s_mov_b64 exec, -1
k3_kernel_fgot:
    s_barrier
    s_mov_b32 s12, s26
    s_mov_b32 s13, s27
    s_mov_b32 s14, 0x240000
    s_mov_b32 s15, 0x00020000
    v_mov_b32 v7, 0xffff0000
    s_cmp_lg_u32 s28, 0
    s_cbranch_scc1 k3_kernel_two
    s_add_u32 s41, s40, 0
    s_lshr_b32 s42, s41, 1
    s_and_b32 s43, s41, 1
    s_lshl_b32 s44, s30, 2
    s_lshl_b32 s45, s43, 1
    s_add_u32 s44, s44, s45
    s_mul_i32 s46, s30, 72
    s_add_u32 s46, s46, s41
    s_lshl_b32 s46, s46, 10
    s_cmp_eq_u32 s29, 0
    s_cselect_b32 s47, 0x40000000, s46
    buffer_load_dwordx4 v[160:163], v2, s[20:23], s47 offen sc1
    s_add_u32 s46, s46, 2359296
    s_cmp_eq_u32 s29, 1
    s_cselect_b32 s47, 0x40000000, s46
    buffer_load_dwordx4 v[164:167], v2, s[20:23], s47 offen sc1
    s_add_u32 s46, s46, 2359296
    s_cmp_eq_u32 s29, 2
    s_cselect_b32 s47, 0x40000000, s46
    buffer_load_dwordx4 v[168:171], v2, s[20:23], s47 offen sc1
    s_add_u32 s46, s46, 2359296
    s_cmp_eq_u32 s29, 3
    s_cselect_b32 s47, 0x40000000, s46
    buffer_load_dwordx4 v[172:175], v2, s[20:23], s47 offen sc1
    s_add_u32 s46, s46, 2359296
    s_cmp_eq_u32 s29, 4
    s_cselect_b32 s47, 0x40000000, s46
    buffer_load_dwordx4 v[176:179], v2, s[20:23], s47 offen sc1
    s_add_u32 s46, s46, 2359296
    s_cmp_eq_u32 s29, 5
    s_cselect_b32 s47, 0x40000000, s46
    buffer_load_dwordx4 v[180:183], v2, s[20:23], s47 offen sc1
    s_add_u32 s46, s46, 2359296
    s_cmp_eq_u32 s29, 6
    s_cselect_b32 s47, 0x40000000, s46
    buffer_load_dwordx4 v[184:187], v2, s[20:23], s47 offen sc1
    s_add_u32 s46, s46, 2359296
    s_cmp_eq_u32 s29, 7
    s_cselect_b32 s47, 0x40000000, s46
    buffer_load_dwordx4 v[188:191], v2, s[20:23], s47 offen sc1
    s_lshl_b32 s47, s41, 10
    v_add_u32 v9, s47, v2
    ds_read_b128 v[64:67], v9
    s_add_u32 s41, s40, 4
    s_lshr_b32 s42, s41, 1
    s_and_b32 s43, s41, 1
    s_lshl_b32 s44, s30, 2
    s_lshl_b32 s45, s43, 1
    s_add_u32 s44, s44, s45
    s_mul_i32 s46, s30, 72
    s_add_u32 s46, s46, s41
    s_lshl_b32 s46, s46, 10
    s_cmp_eq_u32 s29, 0
    s_cselect_b32 s47, 0x40000000, s46
    buffer_load_dwordx4 v[192:195], v2, s[20:23], s47 offen sc1
    s_add_u32 s46, s46, 2359296
    s_cmp_eq_u32 s29, 1
    s_cselect_b32 s47, 0x40000000, s46
    buffer_load_dwordx4 v[196:199], v2, s[20:23], s47 offen sc1
    s_add_u32 s46, s46, 2359296
    s_cmp_eq_u32 s29, 2
    s_cselect_b32 s47, 0x40000000, s46
    buffer_load_dwordx4 v[200:203], v2, s[20:23], s47 offen sc1
    s_add_u32 s46, s46, 2359296
    s_cmp_eq_u32 s29, 3
    s_cselect_b32 s47, 0x40000000, s46
    buffer_load_dwordx4 v[204:207], v2, s[20:23], s47 offen sc1
    s_add_u32 s46, s46, 2359296
    s_cmp_eq_u32 s29, 4
    s_cselect_b32 s47, 0x40000000, s46
    buffer_load_dwordx4 v[208:211], v2, s[20:23], s47 offen sc1
    s_add_u32 s46, s46, 2359296
    s_cmp_eq_u32 s29, 5
    s_cselect_b32 s47, 0x40000000, s46
    buffer_load_dwordx4 v[212:215], v2, s[20:23], s47 offen sc1
    s_add_u32 s46, s46, 2359296
    s_cmp_eq_u32 s29, 6
    s_cselect_b32 s47, 0x40000000, s46
    buffer_load_dwordx4 v[216:219], v2, s[20:23], s47 offen sc1
    s_add_u32 s46, s46, 2359296
    s_cmp_eq_u32 s29, 7
    s_cselect_b32 s47, 0x40000000, s46
    buffer_load_dwordx4 v[220:223], v2, s[20:23], s47 offen sc1
    s_lshl_b32 s47, s41, 10
    v_add_u32 v9, s47, v2
    ds_read_b128 v[68:71], v9
    s_add_u32 s41, s40, 8
    s_lshr_b32 s42, s41, 1
    s_and_b32 s43, s41, 1
    s_lshl_b32 s44, s30, 2
    s_lshl_b32 s45, s43, 1
    s_add_u32 s44, s44, s45
    s_mul_i32 s46, s30, 72
    s_add_u32 s46, s46, s41
    s_lshl_b32 s46, s46, 10
    s_cmp_eq_u32 s29, 0
    s_cselect_b32 s47, 0x40000000, s46
    buffer_load_dwordx4 v[224:227], v2, s[20:23], s47 offen sc1
    s_add_u32 s46, s46, 2359296
    s_cmp_eq_u32 s29, 1
    s_cselect_b32 s47, 0x40000000, s46
    buffer_load_dwordx4 v[228:231], v2, s[20:23], s47 offen sc1
    s_add_u32 s46, s46, 2359296
    s_cmp_eq_u32 s29, 2
    s_cselect_b32 s47, 0x40000000, s46
    buffer_load_dwordx4 v[232:235], v2, s[20:23], s47 offen sc1
    s_add_u32 s46, s46, 2359296
    s_cmp_eq_u32 s29, 3
    s_cselect_b32 s47, 0x40000000, s46
    buffer_load_dwordx4 v[236:239], v2, s[20:23], s47 offen sc1
    s_add_u32 s46, s46, 2359296
    s_cmp_eq_u32 s29, 4
    s_cselect_b32 s47, 0x40000000, s46
    buffer_load_dwordx4 v[240:243], v2, s[20:23], s47 offen sc1
    s_add_u32 s46, s46, 2359296
    s_cmp_eq_u32 s29, 5
    s_cselect_b32 s47, 0x40000000, s46
    buffer_load_dwordx4 v[244:247], v2, s[20:23], s47 offen sc1
    s_add_u32 s46, s46, 2359296
    s_cmp_eq_u32 s29, 6
    s_cselect_b32 s47, 0x40000000, s46
    buffer_load_dwordx4 v[248:251], v2, s[20:23], s47 offen sc1
    s_add_u32 s46, s46, 2359296
    s_cmp_eq_u32 s29, 7
    s_cselect_b32 s47, 0x40000000, s46
    buffer_load_dwordx4 v[252:255], v2, s[20:23], s47 offen sc1
    s_lshl_b32 s47, s41, 10
    v_add_u32 v9, s47, v2
    ds_read_b128 v[72:75], v9
    s_add_u32 s41, s40, 0
    s_lshr_b32 s42, s41, 1
    s_and_b32 s43, s41, 1
    s_lshl_b32 s44, s30, 2
    s_lshl_b32 s45, s43, 1
    s_add_u32 s44, s44, s45
    s_waitcnt vmcnt(16)
    v_lshlrev_b32 v32, 16, v128
    v_and_b32 v33, v7, v128
    v_lshlrev_b32 v34, 16, v129
    v_and_b32 v35, v7, v129
    v_lshlrev_b32 v36, 16, v130
    v_and_b32 v37, v7, v130
    v_lshlrev_b32 v38, 16, v131
    v_and_b32 v39, v7, v131
    v_lshlrev_b32 v40, 16, v132
    v_and_b32 v41, v7, v132
    v_lshlrev_b32 v42, 16, v133
    v_and_b32 v43, v7, v133
    v_add_f32 v32, v32, v40
    v_add_f32 v36, v36, v40
    v_add_f32 v33, v33, v41
    v_add_f32 v37, v37, v41
    v_add_f32 v34, v34, v42
    v_add_f32 v38, v38, v42
    v_add_f32 v35, v35, v43
    v_add_f32 v39, v39, v43
    s_waitcnt lgkmcnt(0)
    v_lshlrev_b32 v44, 16, v64
    v_and_b32 v45, v7, v64
    v_lshlrev_b32 v46, 16, v65
    v_and_b32 v47, v7, v65
    v_lshlrev_b32 v48, 16, v66
    v_and_b32 v49, v7, v66
    v_lshlrev_b32 v50, 16, v67
    v_and_b32 v51, v7, v67
    v_lshlrev_b32 v40, 16, v160
    v_and_b32 v41, v7, v160
    v_add_f32 v44, v44, v40
    v_add_f32 v45, v45, v41
    v_lshlrev_b32 v40, 16, v161
    v_and_b32 v41, v7, v161
    v_add_f32 v46, v46, v40
    v_add_f32 v47, v47, v41
    v_lshlrev_b32 v40, 16, v162
    v_and_b32 v41, v7, v162
    v_add_f32 v48, v48, v40
    v_add_f32 v49, v49, v41
    v_lshlrev_b32 v40, 16, v163
    v_and_b32 v41, v7, v163
    v_add_f32 v50, v50, v40
    v_add_f32 v51, v51, v41
    v_lshlrev_b32 v40, 16, v164
    v_and_b32 v41, v7, v164
    v_add_f32 v44, v44, v40
    v_add_f32 v45, v45, v41
    v_lshlrev_b32 v40, 16, v165
    v_and_b32 v41, v7, v165
    v_add_f32 v46, v46, v40
    v_add_f32 v47, v47, v41
    v_lshlrev_b32 v40, 16, v166
    v_and_b32 v41, v7, v166
    v_add_f32 v48, v48, v40
    v_add_f32 v49, v49, v41
    v_lshlrev_b32 v40, 16, v167
    v_and_b32 v41, v7, v167
    v_add_f32 v50, v50, v40
    v_add_f32 v51, v51, v41
    v_lshlrev_b32 v40, 16, v168
    v_and_b32 v41, v7, v168
    v_add_f32 v44, v44, v40
    v_add_f32 v45, v45, v41
    v_lshlrev_b32 v40, 16, v169
    v_and_b32 v41, v7, v169
    v_add_f32 v46, v46, v40
    v_add_f32 v47, v47, v41
    v_lshlrev_b32 v40, 16, v170
    v_and_b32 v41, v7, v170
    v_add_f32 v48, v48, v40
    v_add_f32 v49, v49, v41
    v_lshlrev_b32 v40, 16, v171
    v_and_b32 v41, v7, v171
    v_add_f32 v50, v50, v40
    v_add_f32 v51, v51, v41
    v_lshlrev_b32 v40, 16, v172
    v_and_b32 v41, v7, v172
    v_add_f32 v44, v44, v40
    v_add_f32 v45, v45, v41
    v_lshlrev_b32 v40, 16, v173
    v_and_b32 v41, v7, v173
    v_add_f32 v46, v46, v40
    v_add_f32 v47, v47, v41
    v_lshlrev_b32 v40, 16, v174
    v_and_b32 v41, v7, v174
    v_add_f32 v48, v48, v40
    v_add_f32 v49, v49, v41
    v_lshlrev_b32 v40, 16, v175
    v_and_b32 v41, v7, v175
    v_add_f32 v50, v50, v40
    v_add_f32 v51, v51, v41
    v_lshlrev_b32 v40, 16, v176
    v_and_b32 v41, v7, v176
    v_add_f32 v44, v44, v40
    v_add_f32 v45, v45, v41
    v_lshlrev_b32 v40, 16, v177
    v_and_b32 v41, v7, v177
    v_add_f32 v46, v46, v40
    v_add_f32 v47, v47, v41
    v_lshlrev_b32 v40, 16, v178
    v_and_b32 v41, v7, v178
    v_add_f32 v48, v48, v40
    v_add_f32 v49, v49, v41
    v_lshlrev_b32 v40, 16, v179
    v_and_b32 v41, v7, v179
    v_add_f32 v50, v50, v40
    v_add_f32 v51, v51, v41
    v_lshlrev_b32 v40, 16, v180
    v_and_b32 v41, v7, v180
    v_add_f32 v44, v44, v40
    v_add_f32 v45, v45, v41
    v_lshlrev_b32 v40, 16, v181
    v_and_b32 v41, v7, v181
    v_add_f32 v46, v46, v40
    v_add_f32 v47, v47, v41
    v_lshlrev_b32 v40, 16, v182
    v_and_b32 v41, v7, v182
    v_add_f32 v48, v48, v40
    v_add_f32 v49, v49, v41
    v_lshlrev_b32 v40, 16, v183
    v_and_b32 v41, v7, v183
    v_add_f32 v50, v50, v40
    v_add_f32 v51, v51, v41
    v_lshlrev_b32 v40, 16, v184
    v_and_b32 v41, v7, v184
    v_add_f32 v44, v44, v40
    v_add_f32 v45, v45, v41
    v_lshlrev_b32 v40, 16, v185
    v_and_b32 v41, v7, v185
    v_add_f32 v46, v46, v40
    v_add_f32 v47, v47, v41
    v_lshlrev_b32 v40, 16, v186
    v_and_b32 v41, v7, v186
    v_add_f32 v48, v48, v40
    v_add_f32 v49, v49, v41
    v_lshlrev_b32 v40, 16, v187
    v_and_b32 v41, v7, v187
    v_add_f32 v50, v50, v40
    v_add_f32 v51, v51, v41
    v_lshlrev_b32 v40, 16, v188
    v_and_b32 v41, v7, v188
    v_add_f32 v44, v44, v40
    v_add_f32 v45, v45, v41
    v_lshlrev_b32 v40, 16, v189
    v_and_b32 v41, v7, v189
    v_add_f32 v46, v46, v40
    v_add_f32 v47, v47, v41
    v_lshlrev_b32 v40, 16, v190
    v_and_b32 v41, v7, v190
    v_add_f32 v48, v48, v40
    v_add_f32 v49, v49, v41
    v_lshlrev_b32 v40, 16, v191
    v_and_b32 v41, v7, v191
    v_add_f32 v50, v50, v40
    v_add_f32 v51, v51, v41
    v_add_f32 v32, v32, v44
    v_add_f32 v33, v33, v45
    v_add_f32 v34, v34, v46
    v_add_f32 v35, v35, v47
    v_add_f32 v36, v36, v48
    v_add_f32 v37, v37, v49
    v_add_f32 v38, v38, v50
    v_add_f32 v39, v39, v51
    v_cvt_pk_bf16_f32 v52, v32, v33
    v_cvt_pk_bf16_f32 v53, v34, v35
    v_cvt_pk_bf16_f32 v54, v36, v37
    v_cvt_pk_bf16_f32 v55, v38, v39
    s_lshl_b32 s46, s44, 4
    v_add_u32 v8, s46, v4
    v_mul_u32_u24 v8, 1152, v8
    v_add_u32 v8, v8, v3
    s_lshl_b32 s47, s42, 5
    buffer_store_dwordx2 v[52:53], v8, s[12:15], s47 offen
    s_add_u32 s47, s47, 18432
    buffer_store_dwordx2 v[54:55], v8, s[12:15], s47 offen
    s_add_u32 s41, s40, 4
    s_lshr_b32 s42, s41, 1
    s_and_b32 s43, s41, 1
    s_lshl_b32 s44, s30, 2
    s_lshl_b32 s45, s43, 1
    s_add_u32 s44, s44, s45
    s_waitcnt vmcnt(10)
    v_lshlrev_b32 v32, 16, v136
    v_and_b32 v33, v7, v136
    v_lshlrev_b32 v34, 16, v137
    v_and_b32 v35, v7, v137
    v_lshlrev_b32 v36, 16, v138
    v_and_b32 v37, v7, v138
    v_lshlrev_b32 v38, 16, v139
    v_and_b32 v39, v7, v139
    v_lshlrev_b32 v40, 16, v140
    v_and_b32 v41, v7, v140
    v_lshlrev_b32 v42, 16, v141
    v_and_b32 v43, v7, v141
    v_add_f32 v32, v32, v40
    v_add_f32 v36, v36, v40
    v_add_f32 v33, v33, v41
    v_add_f32 v37, v37, v41
    v_add_f32 v34, v34, v42
    v_add_f32 v38, v38, v42
    v_add_f32 v35, v35, v43
    v_add_f32 v39, v39, v43
    s_waitcnt lgkmcnt(0)
    v_lshlrev_b32 v44, 16, v68
    v_and_b32 v45, v7, v68
    v_lshlrev_b32 v46, 16, v69
    v_and_b32 v47, v7, v69
    v_lshlrev_b32 v48, 16, v70
    v_and_b32 v49, v7, v70
    v_lshlrev_b32 v50, 16, v71
    v_and_b32 v51, v7, v71
    v_lshlrev_b32 v40, 16, v192
    v_and_b32 v41, v7, v192
    v_add_f32 v44, v44, v40
    v_add_f32 v45, v45, v41
    v_lshlrev_b32 v40, 16, v193
    v_and_b32 v41, v7, v193
    v_add_f32 v46, v46, v40
    v_add_f32 v47, v47, v41
    v_lshlrev_b32 v40, 16, v194
    v_and_b32 v41, v7, v194
    v_add_f32 v48, v48, v40
    v_add_f32 v49, v49, v41
    v_lshlrev_b32 v40, 16, v195
    v_and_b32 v41, v7, v195
    v_add_f32 v50, v50, v40
    v_add_f32 v51, v51, v41
    v_lshlrev_b32 v40, 16, v196
    v_and_b32 v41, v7, v196
    v_add_f32 v44, v44, v40
    v_add_f32 v45, v45, v41
    v_lshlrev_b32 v40, 16, v197
    v_and_b32 v41, v7, v197
    v_add_f32 v46, v46, v40
    v_add_f32 v47, v47, v41
    v_lshlrev_b32 v40, 16, v198
    v_and_b32 v41, v7, v198
    v_add_f32 v48, v48, v40
    v_add_f32 v49, v49, v41
    v_lshlrev_b32 v40, 16, v199
    v_and_b32 v41, v7, v199
    v_add_f32 v50, v50, v40
    v_add_f32 v51, v51, v41
    v_lshlrev_b32 v40, 16, v200
    v_and_b32 v41, v7, v200
    v_add_f32 v44, v44, v40
    v_add_f32 v45, v45, v41
    v_lshlrev_b32 v40, 16, v201
    v_and_b32 v41, v7, v201
    v_add_f32 v46, v46, v40
    v_add_f32 v47, v47, v41
    v_lshlrev_b32 v40, 16, v202
    v_and_b32 v41, v7, v202
    v_add_f32 v48, v48, v40
    v_add_f32 v49, v49, v41
    v_lshlrev_b32 v40, 16, v203
    v_and_b32 v41, v7, v203
    v_add_f32 v50, v50, v40
    v_add_f32 v51, v51, v41
    v_lshlrev_b32 v40, 16, v204
    v_and_b32 v41, v7, v204
    v_add_f32 v44, v44, v40
    v_add_f32 v45, v45, v41
    v_lshlrev_b32 v40, 16, v205
    v_and_b32 v41, v7, v205
    v_add_f32 v46, v46, v40
    v_add_f32 v47, v47, v41
    v_lshlrev_b32 v40, 16, v206
    v_and_b32 v41, v7, v206
    v_add_f32 v48, v48, v40
    v_add_f32 v49, v49, v41
    v_lshlrev_b32 v40, 16, v207
    v_and_b32 v41, v7, v207
    v_add_f32 v50, v50, v40
    v_add_f32 v51, v51, v41
    v_lshlrev_b32 v40, 16, v208
    v_and_b32 v41, v7, v208
    v_add_f32 v44, v44, v40
    v_add_f32 v45, v45, v41
    v_lshlrev_b32 v40, 16, v209
    v_and_b32 v41, v7, v209
    v_add_f32 v46, v46, v40
    v_add_f32 v47, v47, v41
    v_lshlrev_b32 v40, 16, v210
    v_and_b32 v41, v7, v210
    v_add_f32 v48, v48, v40
    v_add_f32 v49, v49, v41
    v_lshlrev_b32 v40, 16, v211
    v_and_b32 v41, v7, v211
    v_add_f32 v50, v50, v40
    v_add_f32 v51, v51, v41
    v_lshlrev_b32 v40, 16, v212
    v_and_b32 v41, v7, v212
    v_add_f32 v44, v44, v40
    v_add_f32 v45, v45, v41
    v_lshlrev_b32 v40, 16, v213
    v_and_b32 v41, v7, v213
    v_add_f32 v46, v46, v40
    v_add_f32 v47, v47, v41
    v_lshlrev_b32 v40, 16, v214
    v_and_b32 v41, v7, v214
    v_add_f32 v48, v48, v40
    v_add_f32 v49, v49, v41
    v_lshlrev_b32 v40, 16, v215
    v_and_b32 v41, v7, v215
    v_add_f32 v50, v50, v40
    v_add_f32 v51, v51, v41
    v_lshlrev_b32 v40, 16, v216
    v_and_b32 v41, v7, v216
    v_add_f32 v44, v44, v40
    v_add_f32 v45, v45, v41
    v_lshlrev_b32 v40, 16, v217
    v_and_b32 v41, v7, v217
    v_add_f32 v46, v46, v40
    v_add_f32 v47, v47, v41
    v_lshlrev_b32 v40, 16, v218
    v_and_b32 v41, v7, v218
    v_add_f32 v48, v48, v40
    v_add_f32 v49, v49, v41
    v_lshlrev_b32 v40, 16, v219
    v_and_b32 v41, v7, v219
    v_add_f32 v50, v50, v40
    v_add_f32 v51, v51, v41
    v_lshlrev_b32 v40, 16, v220
    v_and_b32 v41, v7, v220
    v_add_f32 v44, v44, v40
    v_add_f32 v45, v45, v41
    v_lshlrev_b32 v40, 16, v221
    v_and_b32 v41, v7, v221
    v_add_f32 v46, v46, v40
    v_add_f32 v47, v47, v41
    v_lshlrev_b32 v40, 16, v222
    v_and_b32 v41, v7, v222
    v_add_f32 v48, v48, v40
    v_add_f32 v49, v49, v41
    v_lshlrev_b32 v40, 16, v223
    v_and_b32 v41, v7, v223
    v_add_f32 v50, v50, v40
    v_add_f32 v51, v51, v41
    v_add_f32 v32, v32, v44
    v_add_f32 v33, v33, v45
    v_add_f32 v34, v34, v46
    v_add_f32 v35, v35, v47
    v_add_f32 v36, v36, v48
    v_add_f32 v37, v37, v49
    v_add_f32 v38, v38, v50
    v_add_f32 v39, v39, v51
    v_cvt_pk_bf16_f32 v56, v32, v33
    v_cvt_pk_bf16_f32 v57, v34, v35
    v_cvt_pk_bf16_f32 v58, v36, v37
    v_cvt_pk_bf16_f32 v59, v38, v39
    s_lshl_b32 s46, s44, 4
    v_add_u32 v8, s46, v4
    v_mul_u32_u24 v8, 1152, v8
    v_add_u32 v8, v8, v3
    s_lshl_b32 s47, s42, 5
    buffer_store_dwordx2 v[56:57], v8, s[12:15], s47 offen
    s_add_u32 s47, s47, 18432
    buffer_store_dwordx2 v[58:59], v8, s[12:15], s47 offen
    s_add_u32 s41, s40, 8
    s_lshr_b32 s42, s41, 1
    s_and_b32 s43, s41, 1
    s_lshl_b32 s44, s30, 2
    s_lshl_b32 s45, s43, 1
    s_add_u32 s44, s44, s45
    s_waitcnt vmcnt(4)
    v_lshlrev_b32 v32, 16, v144
    v_and_b32 v33, v7, v144
    v_lshlrev_b32 v34, 16, v145
    v_and_b32 v35, v7, v145
    v_lshlrev_b32 v36, 16, v146
    v_and_b32 v37, v7, v146
    v_lshlrev_b32 v38, 16, v147
    v_and_b32 v39, v7, v147
    v_lshlrev_b32 v40, 16, v148
    v_and_b32 v41, v7, v148
    v_lshlrev_b32 v42, 16, v149
    v_and_b32 v43, v7, v149
    v_add_f32 v32, v32, v40
    v_add_f32 v36, v36, v40
    v_add_f32 v33, v33, v41
    v_add_f32 v37, v37, v41
    v_add_f32 v34, v34, v42
    v_add_f32 v38, v38, v42
    v_add_f32 v35, v35, v43
    v_add_f32 v39, v39, v43
    s_waitcnt lgkmcnt(0)
    v_lshlrev_b32 v44, 16, v72
    v_and_b32 v45, v7, v72
    v_lshlrev_b32 v46, 16, v73
    v_and_b32 v47, v7, v73
    v_lshlrev_b32 v48, 16, v74
    v_and_b32 v49, v7, v74
    v_lshlrev_b32 v50, 16, v75
    v_and_b32 v51, v7, v75
    v_lshlrev_b32 v40, 16, v224
    v_and_b32 v41, v7, v224
    v_add_f32 v44, v44, v40
    v_add_f32 v45, v45, v41
    v_lshlrev_b32 v40, 16, v225
    v_and_b32 v41, v7, v225
    v_add_f32 v46, v46, v40
    v_add_f32 v47, v47, v41
    v_lshlrev_b32 v40, 16, v226
    v_and_b32 v41, v7, v226
    v_add_f32 v48, v48, v40
    v_add_f32 v49, v49, v41
    v_lshlrev_b32 v40, 16, v227
    v_and_b32 v41, v7, v227
    v_add_f32 v50, v50, v40
    v_add_f32 v51, v51, v41
    v_lshlrev_b32 v40, 16, v228
    v_and_b32 v41, v7, v228
    v_add_f32 v44, v44, v40
    v_add_f32 v45, v45, v41
    v_lshlrev_b32 v40, 16, v229
    v_and_b32 v41, v7, v229
    v_add_f32 v46, v46, v40
    v_add_f32 v47, v47, v41
    v_lshlrev_b32 v40, 16, v230
    v_and_b32 v41, v7, v230
    v_add_f32 v48, v48, v40
    v_add_f32 v49, v49, v41
    v_lshlrev_b32 v40, 16, v231
    v_and_b32 v41, v7, v231
    v_add_f32 v50, v50, v40
    v_add_f32 v51, v51, v41
    v_lshlrev_b32 v40, 16, v232
    v_and_b32 v41, v7, v232
    v_add_f32 v44, v44, v40
    v_add_f32 v45, v45, v41
    v_lshlrev_b32 v40, 16, v233
    v_and_b32 v41, v7, v233
    v_add_f32 v46, v46, v40
    v_add_f32 v47, v47, v41
    v_lshlrev_b32 v40, 16, v234
    v_and_b32 v41, v7, v234
    v_add_f32 v48, v48, v40
    v_add_f32 v49, v49, v41
    v_lshlrev_b32 v40, 16, v235
    v_and_b32 v41, v7, v235
    v_add_f32 v50, v50, v40
    v_add_f32 v51, v51, v41
    v_lshlrev_b32 v40, 16, v236
    v_and_b32 v41, v7, v236
    v_add_f32 v44, v44, v40
    v_add_f32 v45, v45, v41
    v_lshlrev_b32 v40, 16, v237
    v_and_b32 v41, v7, v237
    v_add_f32 v46, v46, v40
    v_add_f32 v47, v47, v41
    v_lshlrev_b32 v40, 16, v238
    v_and_b32 v41, v7, v238
    v_add_f32 v48, v48, v40
    v_add_f32 v49, v49, v41
    v_lshlrev_b32 v40, 16, v239
    v_and_b32 v41, v7, v239
    v_add_f32 v50, v50, v40
    v_add_f32 v51, v51, v41
    v_lshlrev_b32 v40, 16, v240
    v_and_b32 v41, v7, v240
    v_add_f32 v44, v44, v40
    v_add_f32 v45, v45, v41
    v_lshlrev_b32 v40, 16, v241
    v_and_b32 v41, v7, v241
    v_add_f32 v46, v46, v40
    v_add_f32 v47, v47, v41
    v_lshlrev_b32 v40, 16, v242
    v_and_b32 v41, v7, v242
    v_add_f32 v48, v48, v40
    v_add_f32 v49, v49, v41
    v_lshlrev_b32 v40, 16, v243
    v_and_b32 v41, v7, v243
    v_add_f32 v50, v50, v40
    v_add_f32 v51, v51, v41
    v_lshlrev_b32 v40, 16, v244
    v_and_b32 v41, v7, v244
    v_add_f32 v44, v44, v40
    v_add_f32 v45, v45, v41
    v_lshlrev_b32 v40, 16, v245
    v_and_b32 v41, v7, v245
    v_add_f32 v46, v46, v40
    v_add_f32 v47, v47, v41
    v_lshlrev_b32 v40, 16, v246
    v_and_b32 v41, v7, v246
    v_add_f32 v48, v48, v40
    v_add_f32 v49, v49, v41
    v_lshlrev_b32 v40, 16, v247
    v_and_b32 v41, v7, v247
    v_add_f32 v50, v50, v40
    v_add_f32 v51, v51, v41
    v_lshlrev_b32 v40, 16, v248
    v_and_b32 v41, v7, v248
    v_add_f32 v44, v44, v40
    v_add_f32 v45, v45, v41
    v_lshlrev_b32 v40, 16, v249
    v_and_b32 v41, v7, v249
    v_add_f32 v46, v46, v40
    v_add_f32 v47, v47, v41
    v_lshlrev_b32 v40, 16, v250
    v_and_b32 v41, v7, v250
    v_add_f32 v48, v48, v40
    v_add_f32 v49, v49, v41
    v_lshlrev_b32 v40, 16, v251
    v_and_b32 v41, v7, v251
    v_add_f32 v50, v50, v40
    v_add_f32 v51, v51, v41
    v_lshlrev_b32 v40, 16, v252
    v_and_b32 v41, v7, v252
    v_add_f32 v44, v44, v40
    v_add_f32 v45, v45, v41
    v_lshlrev_b32 v40, 16, v253
    v_and_b32 v41, v7, v253
    v_add_f32 v46, v46, v40
    v_add_f32 v47, v47, v41
    v_lshlrev_b32 v40, 16, v254
    v_and_b32 v41, v7, v254
    v_add_f32 v48, v48, v40
    v_add_f32 v49, v49, v41
    v_lshlrev_b32 v40, 16, v255
    v_and_b32 v41, v7, v255
    v_add_f32 v50, v50, v40
    v_add_f32 v51, v51, v41
    v_add_f32 v32, v32, v44
    v_add_f32 v33, v33, v45
    v_add_f32 v34, v34, v46
    v_add_f32 v35, v35, v47
    v_add_f32 v36, v36, v48
    v_add_f32 v37, v37, v49
    v_add_f32 v38, v38, v50
    v_add_f32 v39, v39, v51
    v_cvt_pk_bf16_f32 v60, v32, v33
    v_cvt_pk_bf16_f32 v61, v34, v35
    v_cvt_pk_bf16_f32 v62, v36, v37
    v_cvt_pk_bf16_f32 v63, v38, v39
    s_lshl_b32 s46, s44, 4
    v_add_u32 v8, s46, v4
    v_mul_u32_u24 v8, 1152, v8
    v_add_u32 v8, v8, v3
    s_lshl_b32 s47, s42, 5
    buffer_store_dwordx2 v[60:61], v8, s[12:15], s47 offen
    s_add_u32 s47, s47, 18432
    buffer_store_dwordx2 v[62:63], v8, s[12:15], s47 offen
    s_branch k3_kernel_rdone
k3_kernel_two:
    s_add_u32 s41, s40, 0
    s_lshr_b32 s42, s41, 1
    s_and_b32 s43, s41, 1
    s_lshl_b32 s44, s30, 2
    s_lshl_b32 s45, s43, 1
    s_add_u32 s44, s44, s45
    s_mul_i32 s46, s30, 72
    s_add_u32 s46, s46, s41
    s_lshl_b32 s46, s46, 10
    s_cmp_eq_u32 s29, 0
    s_cselect_b32 s47, 0x40000000, s46
    buffer_load_dwordx4 v[160:163], v2, s[20:23], s47 offen sc1
    s_add_u32 s46, s46, 2359296
    s_cmp_eq_u32 s29, 1
    s_cselect_b32 s47, 0x40000000, s46
    buffer_load_dwordx4 v[164:167], v2, s[20:23], s47 offen sc1
    s_add_u32 s46, s46, 2359296
    s_cmp_eq_u32 s29, 2
    s_cselect_b32 s47, 0x40000000, s46
    buffer_load_dwordx4 v[168:171], v2, s[20:23], s47 offen sc1
    s_add_u32 s46, s46, 2359296
    s_cmp_eq_u32 s29, 3
    s_cselect_b32 s47, 0x40000000, s46
    buffer_load_dwordx4 v[172:175], v2, s[20:23], s47 offen sc1
    s_add_u32 s46, s46, 2359296
    s_cmp_eq_u32 s29, 4
    s_cselect_b32 s47, 0x40000000, s46
    buffer_load_dwordx4 v[176:179], v2, s[20:23], s47 offen sc1
    s_add_u32 s46, s46, 2359296
    s_cmp_eq_u32 s29, 5
    s_cselect_b32 s47, 0x40000000, s46
    buffer_load_dwordx4 v[180:183], v2, s[20:23], s47 offen sc1
    s_add_u32 s46, s46, 2359296
    s_cmp_eq_u32 s29, 6
    s_cselect_b32 s47, 0x40000000, s46
    buffer_load_dwordx4 v[184:187], v2, s[20:23], s47 offen sc1
    s_add_u32 s46, s46, 2359296
    s_cmp_eq_u32 s29, 7
    s_cselect_b32 s47, 0x40000000, s46
    buffer_load_dwordx4 v[188:191], v2, s[20:23], s47 offen sc1
    s_lshl_b32 s47, s41, 10
    v_add_u32 v9, s47, v2
    ds_read_b128 v[64:67], v9
    s_add_u32 s41, s40, 4
    s_lshr_b32 s42, s41, 1
    s_and_b32 s43, s41, 1
    s_lshl_b32 s44, s30, 2
    s_lshl_b32 s45, s43, 1
    s_add_u32 s44, s44, s45
    s_mul_i32 s46, s30, 72
    s_add_u32 s46, s46, s41
    s_lshl_b32 s46, s46, 10
    s_cmp_eq_u32 s29, 0
    s_cselect_b32 s47, 0x40000000, s46
    buffer_load_dwordx4 v[192:195], v2, s[20:23], s47 offen sc1
    s_add_u32 s46, s46, 2359296
    s_cmp_eq_u32 s29, 1
    s_cselect_b32 s47, 0x40000000, s46
    buffer_load_dwordx4 v[196:199], v2, s[20:23], s47 offen sc1
    s_add_u32 s46, s46, 2359296
    s_cmp_eq_u32 s29, 2
    s_cselect_b32 s47, 0x40000000, s46
    buffer_load_dwordx4 v[200:203], v2, s[20:23], s47 offen sc1
    s_add_u32 s46, s46, 2359296
    s_cmp_eq_u32 s29, 3
    s_cselect_b32 s47, 0x40000000, s46
    buffer_load_dwordx4 v[204:207], v2, s[20:23], s47 offen sc1
    s_add_u32 s46, s46, 2359296
    s_cmp_eq_u32 s29, 4
    s_cselect_b32 s47, 0x40000000, s46
    buffer_load_dwordx4 v[208:211], v2, s[20:23], s47 offen sc1
    s_add_u32 s46, s46, 2359296
    s_cmp_eq_u32 s29, 5
    s_cselect_b32 s47, 0x40000000, s46
    buffer_load_dwordx4 v[212:215], v2, s[20:23], s47 offen sc1
    s_add_u32 s46, s46, 2359296
    s_cmp_eq_u32 s29, 6
    s_cselect_b32 s47, 0x40000000, s46
    buffer_load_dwordx4 v[216:219], v2, s[20:23], s47 offen sc1
    s_add_u32 s46, s46, 2359296
    s_cmp_eq_u32 s29, 7
    s_cselect_b32 s47, 0x40000000, s46
    buffer_load_dwordx4 v[220:223], v2, s[20:23], s47 offen sc1
    s_lshl_b32 s47, s41, 10
    v_add_u32 v9, s47, v2
    ds_read_b128 v[68:71], v9
    s_add_u32 s41, s40, 0
    s_lshr_b32 s42, s41, 1
    s_and_b32 s43, s41, 1
    s_lshl_b32 s44, s30, 2
    s_lshl_b32 s45, s43, 1
    s_add_u32 s44, s44, s45
    s_waitcnt vmcnt(8)
    v_lshlrev_b32 v32, 16, v128
    v_and_b32 v33, v7, v128
    v_lshlrev_b32 v34, 16, v129
    v_and_b32 v35, v7, v129
    v_lshlrev_b32 v36, 16, v130
    v_and_b32 v37, v7, v130
    v_lshlrev_b32 v38, 16, v131
    v_and_b32 v39, v7, v131
    v_lshlrev_b32 v40, 16, v132
    v_and_b32 v41, v7, v132
    v_lshlrev_b32 v42, 16, v133
    v_and_b32 v43, v7, v133
    v_add_f32 v32, v32, v40
    v_add_f32 v36, v36, v40
    v_add_f32 v33, v33, v41
    v_add_f32 v37, v37, v41
    v_add_f32 v34, v34, v42
    v_add_f32 v38, v38, v42
    v_add_f32 v35, v35, v43
    v_add_f32 v39, v39, v43
    s_waitcnt lgkmcnt(0)
    v_lshlrev_b32 v44, 16, v64
    v_and_b32 v45, v7, v64
    v_lshlrev_b32 v46, 16, v65
    v_and_b32 v47, v7, v65
    v_lshlrev_b32 v48, 16, v66
    v_and_b32 v49, v7, v66
    v_lshlrev_b32 v50, 16, v67
    v_and_b32 v51, v7, v67
    v_lshlrev_b32 v40, 16, v160
    v_and_b32 v41, v7, v160
    v_add_f32 v44, v44, v40
    v_add_f32 v45, v45, v41
    v_lshlrev_b32 v40, 16, v161
    v_and_b32 v41, v7, v161
    v_add_f32 v46, v46, v40
    v_add_f32 v47, v47, v41
    v_lshlrev_b32 v40, 16, v162
    v_and_b32 v41, v7, v162
    v_add_f32 v48, v48, v40
    v_add_f32 v49, v49, v41
    v_lshlrev_b32 v40, 16, v163
    v_and_b32 v41, v7, v163
    v_add_f32 v50, v50, v40
    v_add_f32 v51, v51, v41
    v_lshlrev_b32 v40, 16, v164
    v_and_b32 v41, v7, v164
    v_add_f32 v44, v44, v40
    v_add_f32 v45, v45, v41
    v_lshlrev_b32 v40, 16, v165
    v_and_b32 v41, v7, v165
    v_add_f32 v46, v46, v40
    v_add_f32 v47, v47, v41
    v_lshlrev_b32 v40, 16, v166
    v_and_b32 v41, v7, v166
    v_add_f32 v48, v48, v40
    v_add_f32 v49, v49, v41
    v_lshlrev_b32 v40, 16, v167
    v_and_b32 v41, v7, v167
    v_add_f32 v50, v50, v40
    v_add_f32 v51, v51, v41
    v_lshlrev_b32 v40, 16, v168
    v_and_b32 v41, v7, v168
    v_add_f32 v44, v44, v40
    v_add_f32 v45, v45, v41
    v_lshlrev_b32 v40, 16, v169
    v_and_b32 v41, v7, v169
    v_add_f32 v46, v46, v40
    v_add_f32 v47, v47, v41
    v_lshlrev_b32 v40, 16, v170
    v_and_b32 v41, v7, v170
    v_add_f32 v48, v48, v40
    v_add_f32 v49, v49, v41
    v_lshlrev_b32 v40, 16, v171
    v_and_b32 v41, v7, v171
    v_add_f32 v50, v50, v40
    v_add_f32 v51, v51, v41
    v_lshlrev_b32 v40, 16, v172
    v_and_b32 v41, v7, v172
    v_add_f32 v44, v44, v40
    v_add_f32 v45, v45, v41
    v_lshlrev_b32 v40, 16, v173
    v_and_b32 v41, v7, v173
    v_add_f32 v46, v46, v40
    v_add_f32 v47, v47, v41
    v_lshlrev_b32 v40, 16, v174
    v_and_b32 v41, v7, v174
    v_add_f32 v48, v48, v40
    v_add_f32 v49, v49, v41
    v_lshlrev_b32 v40, 16, v175
    v_and_b32 v41, v7, v175
    v_add_f32 v50, v50, v40
    v_add_f32 v51, v51, v41
    v_lshlrev_b32 v40, 16, v176
    v_and_b32 v41, v7, v176
    v_add_f32 v44, v44, v40
    v_add_f32 v45, v45, v41
    v_lshlrev_b32 v40, 16, v177
    v_and_b32 v41, v7, v177
    v_add_f32 v46, v46, v40
    v_add_f32 v47, v47, v41
    v_lshlrev_b32 v40, 16, v178
    v_and_b32 v41, v7, v178
    v_add_f32 v48, v48, v40
    v_add_f32 v49, v49, v41
    v_lshlrev_b32 v40, 16, v179
    v_and_b32 v41, v7, v179
    v_add_f32 v50, v50, v40
    v_add_f32 v51, v51, v41
    v_lshlrev_b32 v40, 16, v180
    v_and_b32 v41, v7, v180
    v_add_f32 v44, v44, v40
    v_add_f32 v45, v45, v41
    v_lshlrev_b32 v40, 16, v181
    v_and_b32 v41, v7, v181
    v_add_f32 v46, v46, v40
    v_add_f32 v47, v47, v41
    v_lshlrev_b32 v40, 16, v182
    v_and_b32 v41, v7, v182
    v_add_f32 v48, v48, v40
    v_add_f32 v49, v49, v41
    v_lshlrev_b32 v40, 16, v183
    v_and_b32 v41, v7, v183
    v_add_f32 v50, v50, v40
    v_add_f32 v51, v51, v41
    v_lshlrev_b32 v40, 16, v184
    v_and_b32 v41, v7, v184
    v_add_f32 v44, v44, v40
    v_add_f32 v45, v45, v41
    v_lshlrev_b32 v40, 16, v185
    v_and_b32 v41, v7, v185
    v_add_f32 v46, v46, v40
    v_add_f32 v47, v47, v41
    v_lshlrev_b32 v40, 16, v186
    v_and_b32 v41, v7, v186
    v_add_f32 v48, v48, v40
    v_add_f32 v49, v49, v41
    v_lshlrev_b32 v40, 16, v187
    v_and_b32 v41, v7, v187
    v_add_f32 v50, v50, v40
    v_add_f32 v51, v51, v41
    v_lshlrev_b32 v40, 16, v188
    v_and_b32 v41, v7, v188
    v_add_f32 v44, v44, v40
    v_add_f32 v45, v45, v41
    v_lshlrev_b32 v40, 16, v189
    v_and_b32 v41, v7, v189
    v_add_f32 v46, v46, v40
    v_add_f32 v47, v47, v41
    v_lshlrev_b32 v40, 16, v190
    v_and_b32 v41, v7, v190
    v_add_f32 v48, v48, v40
    v_add_f32 v49, v49, v41
    v_lshlrev_b32 v40, 16, v191
    v_and_b32 v41, v7, v191
    v_add_f32 v50, v50, v40
    v_add_f32 v51, v51, v41
    v_add_f32 v32, v32, v44
    v_add_f32 v33, v33, v45
    v_add_f32 v34, v34, v46
    v_add_f32 v35, v35, v47
    v_add_f32 v36, v36, v48
    v_add_f32 v37, v37, v49
    v_add_f32 v38, v38, v50
    v_add_f32 v39, v39, v51
    v_cvt_pk_bf16_f32 v52, v32, v33
    v_cvt_pk_bf16_f32 v53, v34, v35
    v_cvt_pk_bf16_f32 v54, v36, v37
    v_cvt_pk_bf16_f32 v55, v38, v39
    s_lshl_b32 s46, s44, 4
    v_add_u32 v8, s46, v4
    v_mul_u32_u24 v8, 1152, v8
    v_add_u32 v8, v8, v3
    s_lshl_b32 s47, s42, 5
    buffer_store_dwordx2 v[52:53], v8, s[12:15], s47 offen
    s_add_u32 s47, s47, 18432
    buffer_store_dwordx2 v[54:55], v8, s[12:15], s47 offen
    s_add_u32 s41, s40, 4
    s_lshr_b32 s42, s41, 1
    s_and_b32 s43, s41, 1
    s_lshl_b32 s44, s30, 2
    s_lshl_b32 s45, s43, 1
    s_add_u32 s44, s44, s45
    s_waitcnt vmcnt(2)
    v_lshlrev_b32 v32, 16, v136
    v_and_b32 v33, v7, v136
    v_lshlrev_b32 v34, 16, v137
    v_and_b32 v35, v7, v137
    v_lshlrev_b32 v36, 16, v138
    v_and_b32 v37, v7, v138
    v_lshlrev_b32 v38, 16, v139
    v_and_b32 v39, v7, v139
    v_lshlrev_b32 v40, 16, v140
    v_and_b32 v41, v7, v140
    v_lshlrev_b32 v42, 16, v141
    v_and_b32 v43, v7, v141
    v_add_f32 v32, v32, v40
    v_add_f32 v36, v36, v40
    v_add_f32 v33, v33, v41
    v_add_f32 v37, v37, v41
    v_add_f32 v34, v34, v42
    v_add_f32 v38, v38, v42
    v_add_f32 v35, v35, v43
    v_add_f32 v39, v39, v43
    s_waitcnt lgkmcnt(0)
    v_lshlrev_b32 v44, 16, v68
    v_and_b32 v45, v7, v68
    v_lshlrev_b32 v46, 16, v69
    v_and_b32 v47, v7, v69
    v_lshlrev_b32 v48, 16, v70
    v_and_b32 v49, v7, v70
    v_lshlrev_b32 v50, 16, v71
    v_and_b32 v51, v7, v71
    v_lshlrev_b32 v40, 16, v192
    v_and_b32 v41, v7, v192
    v_add_f32 v44, v44, v40
    v_add_f32 v45, v45, v41
    v_lshlrev_b32 v40, 16, v193
    v_and_b32 v41, v7, v193
    v_add_f32 v46, v46, v40
    v_add_f32 v47, v47, v41
    v_lshlrev_b32 v40, 16, v194
    v_and_b32 v41, v7, v194
    v_add_f32 v48, v48, v40
    v_add_f32 v49, v49, v41
    v_lshlrev_b32 v40, 16, v195
    v_and_b32 v41, v7, v195
    v_add_f32 v50, v50, v40
    v_add_f32 v51, v51, v41
    v_lshlrev_b32 v40, 16, v196
    v_and_b32 v41, v7, v196
    v_add_f32 v44, v44, v40
    v_add_f32 v45, v45, v41
    v_lshlrev_b32 v40, 16, v197
    v_and_b32 v41, v7, v197
    v_add_f32 v46, v46, v40
    v_add_f32 v47, v47, v41
    v_lshlrev_b32 v40, 16, v198
    v_and_b32 v41, v7, v198
    v_add_f32 v48, v48, v40
    v_add_f32 v49, v49, v41
    v_lshlrev_b32 v40, 16, v199
    v_and_b32 v41, v7, v199
    v_add_f32 v50, v50, v40
    v_add_f32 v51, v51, v41
    v_lshlrev_b32 v40, 16, v200
    v_and_b32 v41, v7, v200
    v_add_f32 v44, v44, v40
    v_add_f32 v45, v45, v41
    v_lshlrev_b32 v40, 16, v201
    v_and_b32 v41, v7, v201
    v_add_f32 v46, v46, v40
    v_add_f32 v47, v47, v41
    v_lshlrev_b32 v40, 16, v202
    v_and_b32 v41, v7, v202
    v_add_f32 v48, v48, v40
    v_add_f32 v49, v49, v41
    v_lshlrev_b32 v40, 16, v203
    v_and_b32 v41, v7, v203
    v_add_f32 v50, v50, v40
    v_add_f32 v51, v51, v41
    v_lshlrev_b32 v40, 16, v204
    v_and_b32 v41, v7, v204
    v_add_f32 v44, v44, v40
    v_add_f32 v45, v45, v41
    v_lshlrev_b32 v40, 16, v205
    v_and_b32 v41, v7, v205
    v_add_f32 v46, v46, v40
    v_add_f32 v47, v47, v41
    v_lshlrev_b32 v40, 16, v206
    v_and_b32 v41, v7, v206
    v_add_f32 v48, v48, v40
    v_add_f32 v49, v49, v41
    v_lshlrev_b32 v40, 16, v207
    v_and_b32 v41, v7, v207
    v_add_f32 v50, v50, v40
    v_add_f32 v51, v51, v41
    v_lshlrev_b32 v40, 16, v208
    v_and_b32 v41, v7, v208
    v_add_f32 v44, v44, v40
    v_add_f32 v45, v45, v41
    v_lshlrev_b32 v40, 16, v209
    v_and_b32 v41, v7, v209
    v_add_f32 v46, v46, v40
    v_add_f32 v47, v47, v41
    v_lshlrev_b32 v40, 16, v210
    v_and_b32 v41, v7, v210
    v_add_f32 v48, v48, v40
    v_add_f32 v49, v49, v41
    v_lshlrev_b32 v40, 16, v211
    v_and_b32 v41, v7, v211
    v_add_f32 v50, v50, v40
    v_add_f32 v51, v51, v41
    v_lshlrev_b32 v40, 16, v212
    v_and_b32 v41, v7, v212
    v_add_f32 v44, v44, v40
    v_add_f32 v45, v45, v41
    v_lshlrev_b32 v40, 16, v213
    v_and_b32 v41, v7, v213
    v_add_f32 v46, v46, v40
    v_add_f32 v47, v47, v41
    v_lshlrev_b32 v40, 16, v214
    v_and_b32 v41, v7, v214
    v_add_f32 v48, v48, v40
    v_add_f32 v49, v49, v41
    v_lshlrev_b32 v40, 16, v215
    v_and_b32 v41, v7, v215
    v_add_f32 v50, v50, v40
    v_add_f32 v51, v51, v41
    v_lshlrev_b32 v40, 16, v216
    v_and_b32 v41, v7, v216
    v_add_f32 v44, v44, v40
    v_add_f32 v45, v45, v41
    v_lshlrev_b32 v40, 16, v217
    v_and_b32 v41, v7, v217
    v_add_f32 v46, v46, v40
    v_add_f32 v47, v47, v41
    v_lshlrev_b32 v40, 16, v218
    v_and_b32 v41, v7, v218
    v_add_f32 v48, v48, v40
    v_add_f32 v49, v49, v41
    v_lshlrev_b32 v40, 16, v219
    v_and_b32 v41, v7, v219
    v_add_f32 v50, v50, v40
    v_add_f32 v51, v51, v41
    v_lshlrev_b32 v40, 16, v220
    v_and_b32 v41, v7, v220
    v_add_f32 v44, v44, v40
    v_add_f32 v45, v45, v41
    v_lshlrev_b32 v40, 16, v221
    v_and_b32 v41, v7, v221
    v_add_f32 v46, v46, v40
    v_add_f32 v47, v47, v41
    v_lshlrev_b32 v40, 16, v222
    v_and_b32 v41, v7, v222
    v_add_f32 v48, v48, v40
    v_add_f32 v49, v49, v41
    v_lshlrev_b32 v40, 16, v223
    v_and_b32 v41, v7, v223
    v_add_f32 v50, v50, v40
    v_add_f32 v51, v51, v41
    v_add_f32 v32, v32, v44
    v_add_f32 v33, v33, v45
    v_add_f32 v34, v34, v46
    v_add_f32 v35, v35, v47
    v_add_f32 v36, v36, v48
    v_add_f32 v37, v37, v49
    v_add_f32 v38, v38, v50
    v_add_f32 v39, v39, v51
    v_cvt_pk_bf16_f32 v56, v32, v33
    v_cvt_pk_bf16_f32 v57, v34, v35
    v_cvt_pk_bf16_f32 v58, v36, v37
    v_cvt_pk_bf16_f32 v59, v38, v39
    s_lshl_b32 s46, s44, 4
    v_add_u32 v8, s46, v4
    v_mul_u32_u24 v8, 1152, v8
    v_add_u32 v8, v8, v3
    s_lshl_b32 s47, s42, 5
    buffer_store_dwordx2 v[56:57], v8, s[12:15], s47 offen
    s_add_u32 s47, s47, 18432
    buffer_store_dwordx2 v[58:59], v8, s[12:15], s47 offen
k3_kernel_rdone:
k3_kernel_done:
    s_endpgm
k3_kernel_end:

    s_nop 0
    s_nop 0
    s_nop 0
    s_nop 0
    s_nop 0
    s_nop 0
    s_nop 0
    s_nop 0
    s_nop 0
    s_nop 0
    s_nop 0
    s_nop 0
    s_nop 0
    s_nop 0
    s_nop 0
    s_nop 0
    s_nop 0
    s_nop 0
    s_nop 0
    s_nop 0
    s_nop 0
    s_nop 0
    s_nop 0
    s_nop 0
    s_nop 0
    s_nop 0
    s_nop 0
    s_nop 0
    s_nop 0
    s_nop 0
    s_nop 0
    s_nop 0
    s_nop 0
    s_nop 0
    s_nop 0
    s_nop 0
    s_nop 0
    s_nop 0
    s_nop 0
    s_nop 0
    s_nop 0
    s_nop 0
    s_nop 0
    s_nop 0
    s_nop 0
    s_nop 0
    s_nop 0
    s_nop 0
    s_nop 0
    s_nop 0
    s_nop 0
    s_nop 0
    s_nop 0
    s_nop 0
    s_nop 0
    s_nop 0
    s_nop 0
    s_nop 0
    s_nop 0
    s_nop 0
    s_nop 0
    s_nop 0
    s_nop 0
    s_nop 0

.section .rodata,"a"
.p2align 6
.amdhsa_kernel k0_kernel
  .amdhsa_next_free_vgpr 144
  .amdhsa_next_free_sgpr 100
  .amdhsa_accum_offset 144
  .amdhsa_group_segment_fixed_size 0
  .amdhsa_kernarg_size 96
  .amdhsa_user_sgpr_count 2
  .amdhsa_user_sgpr_kernarg_segment_ptr 1
  .amdhsa_system_sgpr_workgroup_id_x 1
  .amdhsa_float_denorm_mode_32 3
  .amdhsa_float_denorm_mode_16_64 3
.end_amdhsa_kernel

.p2align 6
.amdhsa_kernel k1_kernel
  .amdhsa_next_free_vgpr 256
  .amdhsa_next_free_sgpr 100
  .amdhsa_accum_offset 256
  .amdhsa_group_segment_fixed_size 0
  .amdhsa_kernarg_size 96
  .amdhsa_user_sgpr_count 2
  .amdhsa_user_sgpr_kernarg_segment_ptr 1
  .amdhsa_system_sgpr_workgroup_id_x 1
  .amdhsa_float_denorm_mode_32 3
  .amdhsa_float_denorm_mode_16_64 3
.end_amdhsa_kernel

.p2align 6
.amdhsa_kernel k2_kernel
  .amdhsa_next_free_vgpr 256
  .amdhsa_next_free_sgpr 100
  .amdhsa_accum_offset 256
  .amdhsa_group_segment_fixed_size 0
  .amdhsa_kernarg_size 96
  .amdhsa_user_sgpr_count 2
  .amdhsa_user_sgpr_kernarg_segment_ptr 1
  .amdhsa_system_sgpr_workgroup_id_x 1
  .amdhsa_float_denorm_mode_32 3
  .amdhsa_float_denorm_mode_16_64 3
.end_amdhsa_kernel

.p2align 6
.amdhsa_kernel k3_kernel
  .amdhsa_next_free_vgpr 512
  .amdhsa_next_free_sgpr 100
  .amdhsa_accum_offset 256
  .amdhsa_group_segment_fixed_size 0
  .amdhsa_kernarg_size 96
  .amdhsa_user_sgpr_count 2
  .amdhsa_user_sgpr_kernarg_segment_ptr 1
  .amdhsa_system_sgpr_workgroup_id_x 1
  .amdhsa_float_denorm_mode_32 3
  .amdhsa_float_denorm_mode_16_64 3
.end_amdhsa_kernel
```
